```python
import torch

def _softmax(x, axis=-1):
    return torch.softmax(x, dim=axis)
def _gelu(x):
    return torch.nn.functional.gelu(x, approximate="tanh")
def _silu(x):
    return torch.nn.functional.silu(x)
def _sigmoid(x):
    return torch.sigmoid(x)
def _layernorm(x, axis=-1, eps=1e-5):
    m = x.mean(dim=axis, keepdim=True)
    v = x.var(dim=axis, keepdim=True, unbiased=False)
    return (x - m) / torch.sqrt(v + eps)
def _scatter_add(tgt, idx, src, axis=0):
    return tgt.clone().index_add_(axis, idx, src)
def _segment_sum(src, seg, n):
    out = torch.zeros((n,) + src.shape[1:], dtype=src.dtype)
    return out.index_add_(0, seg, src)
def _pad(x, pw):
    flat = tuple(v for pair in reversed(pw) for v in pair)
    return torch.nn.functional.pad(x, flat)

kernel_name = 'standalone__mha_block_cached__near_ridge'

def setup_inputs():

    _w = (lambda a: (lambda t: t.to(torch.bfloat16) if t.is_floating_point() else t)(torch.as_tensor(a)))
    B, Sq, D = 16, 96, 512
    H, Sk, Dh = 32, 1024, 128
    return {
        "x": _w((lambda *s: torch.randn(*s, dtype=torch.bfloat16) * 0.8)(B, Sq, D)),
        "k_cache": _w((lambda *s: torch.randn(*s, dtype=torch.bfloat16) * 0.8)(B, H, Sk, Dh)),
        "v_cache": _w((lambda *s: torch.randn(*s, dtype=torch.bfloat16) * 0.05)(B, H, Sk, Dh)),
        "wq": _w((lambda *s: torch.randn(*s, dtype=torch.bfloat16) * 0.8)(D, H * Dh) * (D ** -0.5)),
        "wo": _w((lambda *s: torch.randn(*s, dtype=torch.bfloat16) * 0.05)(H * Dh, D) * ((H * Dh) ** -0.5)),
    }

def reference(x, k_cache, v_cache, wq, wo):
    B, Sq, D = x.shape
    H, Dh = 32, 128
    q = (lambda x, *d: x.permute(*d))((x @ wq).reshape(B, Sq, H, Dh), 0, 2, 1, 3)
    scores = torch.einsum("bhqd,bhkd->bhqk", q, k_cache) * (Dh ** -0.5)
    p = _softmax(scores, axis=-1)
    o = torch.einsum("bhqk,bhkd->bhqd", p, v_cache)
    return (lambda x, *d: x.permute(*d))(o, 0, 2, 1, 3).reshape(B, Sq, H * Dh) @ wo
```

```asm
; @launch grid=(256,1,1) block=(256,1,1) lds=163840
.amdgcn_target "amdgcn-amd-amdhsa--gfx950"
.text
.globl standalone__mha_block_cached__near_ridge_kernel
.p2align 8
.type standalone__mha_block_cached__near_ridge_kernel,@function
standalone__mha_block_cached__near_ridge_kernel:
    s_cmp_ge_u32 s2, 256
    s_cbranch_scc1 L_end
    s_load_dwordx16 s[4:19], s[0:1], 0
    v_lshrrev_b32 v1, 6, v0
    v_and_b32 v0, 63, v0
    v_readfirstlane_b32 s48, v1
    v_lshlrev_b32 v23, 4, v0
    s_getpc_b64 s[68:69]
L_pcref:
    v_lshlrev_b32 v192, 7, v0
    s_nop 0
    s_lshl_b32 s57, s48, 14
    v_add_u32 v192, s57, v192
    v_add_u32 v193, 0x2000, v192
    v_min_u32 v192, L_codeend-L_pcref-4, v192
    v_min_u32 v193, L_codeend-L_pcref-4, v193
    global_load_dword v194, v192, s[68:69]
    global_load_dword v195, v193, s[68:69]
    s_lshr_b32 s49, s48, 1
    s_and_b32 s50, s48, 1
    s_and_b32 s84, s2, 7
    s_lshr_b32 s58, s2, 3
    s_and_b32 s85, s58, 3
    s_lshr_b32 s87, s58, 2
    s_lshl_b32 s51, s84, 2
    s_add_u32 s51, s51, s85
    s_mov_b32 s52, s87
    s_add_u32 s82, s87, 8
    s_lshl_b32 s57, s85, 1
    s_add_u32 s57, s57, s87
    s_and_b32 s83, s57, 7
    s_lshl_b32 s57, s85, 2
    s_lshl_b32 s58, s87, 1
    s_add_u32 s57, s57, s58
    s_and_b32 s71, s57, 15
    s_mov_b32 s22, 0x180000
    s_mov_b32 s23, 0x20000
    s_mov_b32 s34, 0x400000
    s_mov_b32 s35, 0x20000
    s_mov_b32 s26, 0x8000000
    s_mov_b32 s27, 0x20000
    s_mov_b32 s30, 0x8000000
    s_mov_b32 s31, 0x20000
    s_mov_b32 s38, 0x400000
    s_mov_b32 s39, 0x20000
    s_mov_b32 s42, 0x20000000
    s_mov_b32 s43, 0x20000
    s_mov_b32 s46, 0x180000
    s_mov_b32 s47, 0x20000
    s_mov_b32 s98, 0x100
    s_mov_b32 s99, 0x20000
    v_lshrrev_b32 v26, 4, v0
    v_and_b32 v27, 15, v0
    v_lshlrev_b32 v28, 4, v26
    v_lshl_add_u32 v22, v27, 10, v28
    v_lshlrev_b32 v28, 1, v26
    v_xor_b32 v28, v27, v28
    v_lshlrev_b32 v28, 4, v28
    v_lshl_add_u32 v20, v26, 13, v28
    v_xor_b32 v21, 0x80, v20
    v_lshl_add_u32 v6, v26, 8, v28
    v_xor_b32 v7, 0x80, v6
    v_xor_b32 v28, v27, v26
    v_lshlrev_b32 v28, 4, v28
    v_lshl_add_u32 v2, v26, 8, v28
    v_xor_b32 v3, 64, v2
    v_xor_b32 v4, 128, v2
    v_xor_b32 v5, 192, v2
    s_mul_i32 s57, s52, 98304
    s_mul_i32 s58, s48, 24576
    s_add_u32 s61, s57, s58
    s_lshl_b32 s57, s49, 5
    s_lshl_b32 s58, s50, 2
    s_add_u32 s57, s57, s58
    s_lshl_b32 s57, s57, 13
    s_lshl_b32 s58, s51, 8
    s_add_u32 s64, s57, s58
    s_mul_i32 s75, s48, 3072
    s_lshl_b32 s76, s48, 12
    v_lshrrev_b32 v26, 3, v0
    v_and_b32 v27, 7, v0
    v_lshrrev_b32 v32, 4, v0
    v_xor_b32 v27, v27, v32
    v_lshlrev_b32 v27, 4, v27
    v_lshl_add_u32 v32, v26, 10, v27
    s_lshl_b32 s57, s50, 6
    v_xor_b32 v32, s57, v32
    v_xor_b32 v33, 0x40, v32
    v_and_b32 v26, 15, v0
    v_lshrrev_b32 v27, 1, v26
    v_lshrrev_b32 v34, 4, v0
    v_xor_b32 v27, v27, v34
    v_lshlrev_b32 v27, 4, v27
    v_lshl_add_u32 v34, v26, 7, v27
    s_waitcnt lgkmcnt(0)
    s_mov_b32 s20, s4
    s_mov_b32 s21, s5
    s_mov_b32 s32, s10
    s_mov_b32 s33, s11
    s_add_u32 s74, s83, 0
    s_and_b32 s74, s74, 7
    s_lshl_b32 s59, s74, 19
    s_add_u32 s59, s59, s64
    s_add_u32 m0, s76, 57344
    s_add_u32 s58, s59, 0
    buffer_load_dwordx4 v20, s[32:35], s58 offen  lds
    s_add_u32 m0, s76, 58368
    s_add_u32 s58, s59, 65536
    s_mov_b32 s24, s6
    s_mov_b32 s25, s7
    s_mov_b32 s28, s8
    s_mov_b32 s29, s9
    s_mov_b32 s36, s12
    s_mov_b32 s37, s13
    s_mov_b32 s40, s18
    s_mov_b32 s41, s19
    s_mov_b32 s44, s14
    s_mov_b32 s45, s15
    s_mov_b32 s96, s16
    s_mov_b32 s97, s17
    buffer_load_dwordx4 v21, s[32:35], s58 offen  lds
    s_add_u32 m0, s76, 59392
    s_add_u32 s58, s59, 131072
    v_lshrrev_b32 v196, 4, v0
    v_and_b32 v197, 15, v0
    v_xor_b32 v198, v196, v197
    v_lshlrev_b32 v198, 4, v198
    v_lshl_add_u32 v198, v197, 8, v198
    v_mov_b32 v188, 0x3f803f80
    v_mov_b32 v189, 0x3f803f80
    v_mov_b32 v190, 0x3f803f80
    v_mov_b32 v191, 0x3f803f80
    s_mov_b32 s65, 0
    buffer_load_dwordx4 v20, s[32:35], s58 offen  lds
    s_add_u32 m0, s76, 60416
    s_add_u32 s58, s59, 196608
    s_lshl_b32 s59, s74, 7
    s_add_u32 s59, s59, s61
    buffer_load_dwordx4 v21, s[32:35], s58 offen  lds
    s_add_u32 m0, s75, 32768
    s_add_u32 s58, s59, 0
    buffer_load_dwordx4 v32, s[20:23], s58 offen  lds
    s_add_u32 m0, s75, 33792
    s_add_u32 s58, s59, 8192
    buffer_load_dwordx4 v33, s[20:23], s58 offen  lds
    s_add_u32 m0, s75, 34816
    s_add_u32 s58, s59, 16384
    buffer_load_dwordx4 v32, s[20:23], s58 offen  lds
    s_add_u32 m0, s75, 45056
    s_add_u32 s58, s59, 786432
    buffer_load_dwordx4 v32, s[20:23], s58 offen  lds
    s_add_u32 m0, s75, 46080
    s_add_u32 s58, s59, 794624
    buffer_load_dwordx4 v33, s[20:23], s58 offen  lds
    s_add_u32 m0, s75, 47104
    s_add_u32 s58, s59, 802816
    s_add_u32 s74, s83, 1
    s_and_b32 s74, s74, 7
    s_lshl_b32 s59, s74, 19
    s_add_u32 s59, s59, s64
    buffer_load_dwordx4 v32, s[20:23], s58 offen  lds
    s_add_u32 m0, s76, 98304
    s_add_u32 s58, s59, 0
    buffer_load_dwordx4 v20, s[32:35], s58 offen  lds
    s_add_u32 m0, s76, 99328
    s_add_u32 s58, s59, 65536
    buffer_load_dwordx4 v21, s[32:35], s58 offen  lds
    s_add_u32 m0, s76, 100352
    s_add_u32 s58, s59, 131072
    buffer_load_dwordx4 v20, s[32:35], s58 offen  lds
    s_add_u32 m0, s76, 101376
    s_add_u32 s58, s59, 196608
    s_lshl_b32 s59, s74, 7
    s_add_u32 s59, s59, s61
    buffer_load_dwordx4 v21, s[32:35], s58 offen  lds
    s_add_u32 m0, s75, 73728
    s_add_u32 s58, s59, 0
    buffer_load_dwordx4 v32, s[20:23], s58 offen  lds
    s_add_u32 m0, s75, 74752
    s_add_u32 s58, s59, 8192
    buffer_load_dwordx4 v33, s[20:23], s58 offen  lds
    s_add_u32 m0, s75, 75776
    s_add_u32 s58, s59, 16384
    buffer_load_dwordx4 v32, s[20:23], s58 offen  lds
    s_add_u32 m0, s75, 86016
    s_add_u32 s58, s59, 786432
    buffer_load_dwordx4 v32, s[20:23], s58 offen  lds
    s_add_u32 m0, s75, 87040
    s_add_u32 s58, s59, 794624
    buffer_load_dwordx4 v33, s[20:23], s58 offen  lds
    s_add_u32 m0, s75, 88064
    s_add_u32 s58, s59, 802816
    s_lshl_b32 s54, s52, 5
    s_add_u32 s54, s54, s51
    s_lshl_b32 s54, s54, 18
    s_lshl_b32 s57, s48, 12
    s_add_u32 s54, s54, s57
    s_lshl_b32 s55, s48, 12
    s_add_u32 s93, s55, 0x4000
    s_mov_b32 s92, s54
    s_lshl_b32 s60, s50, 13
    v_add_u32 v8, s60, v198
    v_xor_b32 v9, 64, v8
    v_xor_b32 v10, 128, v8
    buffer_load_dwordx4 v32, s[20:23], s58 offen  lds
    v_xor_b32 v11, 192, v8
    v_lshrrev_b32 v198, 2, v0
    v_and_b32 v199, 7, v198
    v_lshlrev_b32 v199, 5, v199
    v_lshl_add_u32 v198, v198, 8, v199
    v_and_b32 v199, 3, v0
    v_lshl_add_u32 v198, v199, 3, v198
    s_add_u32 s60, s60, 0x4000
    s_lshl_b32 s59, s50, 7
    v_xor_b32 v12, s59, v198
    v_add_u32 v12, s60, v12
    v_xor_b32 v13, 32, v12
    v_xor_b32 v14, 64, v12
    v_xor_b32 v15, 96, v12
    v_xor_b32 v16, 128, v12
    v_xor_b32 v17, 160, v12
    v_xor_b32 v18, 192, v12
    v_xor_b32 v19, 224, v12
    s_lshl_b32 s59, s48, 6
    v_xor_b32 v24, s59, v198
    v_xor_b32 v25, 0x20, v24
    s_lshl_b32 s56, s82, 5
    s_add_u32 s56, s56, s51
    s_lshl_b32 s56, s56, 18
    s_lshl_b32 s57, s48, 12
    s_add_u32 s56, s56, s57
    s_lshl_b32 s57, s87, 3
    s_add_u32 s57, s57, s84
    s_lshl_b32 s57, s57, 7
    s_add_u32 s62, s57, 16777216
    s_lshl_b32 s57, s87, 2
    s_add_u32 s57, s57, s85
    s_lshl_b32 s57, s57, 7
    s_add_u32 s63, s57, 16793600
    s_lshl_b32 s57, s84, 9
    s_lshl_b32 s58, s48, 3
    s_add_u32 s57, s57, s58
    s_lshl_b32 s57, s57, 10
    s_lshl_b32 s58, s85, 8
    s_add_u32 s72, s57, s58
    s_lshl_b32 s57, s87, 5
    s_lshl_b32 s58, s84, 2
    s_add_u32 s57, s57, s58
    s_mul_i32 s73, s57, 24576
    s_lshl_b32 s57, s87, 2
    s_add_u32 s57, s57, s85
    s_lshl_b32 s57, s57, 3
    s_add_u32 s57, s57, s84
    s_mul_i32 s57, s57, 24576
    s_mul_i32 s58, s48, 6144
    s_add_u32 s57, s57, s58
    s_add_u32 s88, s57, 17825792
    s_cmp_lt_u32 s2, 8
    s_cselect_b32 s94, 1, 0
    s_cmp_eq_u32 s48, 0
    s_cselect_b32 s94, s94, 0
    s_cmp_lg_u32 s48, 0
    s_cbranch_scc1 L_w0_1
    v_mov_b32 v204, 0
    v_mov_b32 v205, 0
    s_mov_b64 exec, 1
    s_lshl_b32 s59, s85, 2
    s_add_u32 s59, s59, s62
    buffer_store_dword v204, v205, s[40:43], s59 offen sc1
    s_lshl_b32 s59, s85, 2
    s_add_u32 s59, s59, s62
    s_add_u32 s59, s59, 8192
    buffer_store_dword v204, v205, s[40:43], s59 offen sc1
    s_lshl_b32 s59, s84, 2
    s_add_u32 s59, s59, s63
    buffer_store_dword v204, v205, s[40:43], s59 offen sc1
    s_lshl_b32 s59, s84, 2
    s_add_u32 s59, s59, s63
    s_add_u32 s59, s59, 4096
    buffer_store_dword v204, v205, s[40:43], s59 offen sc1
    s_mov_b64 exec, -1
L_w0_1:
    s_waitcnt vmcnt(10)
    s_barrier
    s_add_u32 s74, s83, 2
    s_and_b32 s74, s74, 7
    s_lshl_b32 s59, s74, 19
    s_add_u32 s59, s59, s64
    s_add_u32 m0, s76, 139264
    s_add_u32 s58, s59, 0
    buffer_load_dwordx4 v20, s[32:35], s58 offen  lds
    s_add_u32 m0, s76, 140288
    s_add_u32 s58, s59, 65536
    v_add_u32 v36, 32768, v34
    v_xor_b32 v37, 0x40, v36
    v_add_u32 v38, 57344, v24
    v_add_u32 v39, 57344, v25
    ds_read_b64_tr_b16 a[0:1], v38 offset:0
    ds_read_b64_tr_b16 a[2:3], v38 offset:4096
    ds_read_b64_tr_b16 a[4:5], v39 offset:0
    ds_read_b64_tr_b16 a[6:7], v39 offset:4096
    buffer_load_dwordx4 v21, s[32:35], s58 offen  lds
    s_add_u32 m0, s76, 141312
    s_add_u32 s58, s59, 131072
    ds_read_b128 a[16:19], v36 offset:0
    ds_read_b128 a[20:23], v36 offset:2048
    ds_read_b128 a[24:27], v36 offset:4096
    buffer_load_dwordx4 v20, s[32:35], s58 offen  lds
    s_add_u32 m0, s76, 142336
    s_add_u32 s58, s59, 196608
    s_lshl_b32 s59, s74, 7
    s_add_u32 s59, s59, s61
    ds_read_b128 a[28:31], v36 offset:6144
    ds_read_b128 a[32:35], v36 offset:8192
    ds_read_b128 a[36:39], v36 offset:10240
    buffer_load_dwordx4 v21, s[32:35], s58 offen  lds
    s_add_u32 m0, s75, 114688
    s_add_u32 s58, s59, 0
    ds_read_b128 a[64:67], v36 offset:12288
    ds_read_b128 a[68:71], v36 offset:14336
    ds_read_b128 a[72:75], v36 offset:16384
    buffer_load_dwordx4 v32, s[20:23], s58 offen  lds
    s_add_u32 m0, s75, 115712
    s_add_u32 s58, s59, 8192
    ds_read_b128 a[76:79], v36 offset:18432
    ds_read_b128 a[80:83], v36 offset:20480
    ds_read_b128 a[84:87], v36 offset:22528
    buffer_load_dwordx4 v33, s[20:23], s58 offen  lds
    s_add_u32 m0, s75, 116736
    s_add_u32 s58, s59, 16384
    ds_read_b64_tr_b16 a[8:9], v38 offset:8192
    ds_read_b64_tr_b16 a[10:11], v38 offset:12288
    ds_read_b64_tr_b16 a[12:13], v39 offset:8192
    ds_read_b64_tr_b16 a[14:15], v39 offset:12288
    ds_read_b128 a[40:43], v37 offset:0
    buffer_load_dwordx4 v32, s[20:23], s58 offen  lds
    s_add_u32 m0, s75, 126976
    s_add_u32 s58, s59, 786432
    ds_read_b128 a[44:47], v37 offset:2048
    ds_read_b128 a[48:51], v37 offset:4096
    ds_read_b128 a[52:55], v37 offset:6144
    buffer_load_dwordx4 v32, s[20:23], s58 offen  lds
    s_add_u32 m0, s75, 128000
    s_add_u32 s58, s59, 794624
    ds_read_b128 a[56:59], v37 offset:8192
    ds_read_b128 a[60:63], v37 offset:10240
    ds_read_b128 a[88:91], v37 offset:12288
    buffer_load_dwordx4 v33, s[20:23], s58 offen  lds
    s_add_u32 m0, s75, 129024
    s_add_u32 s58, s59, 802816
    ds_read_b128 a[92:95], v37 offset:14336
    ds_read_b128 a[96:99], v37 offset:16384
    ds_read_b128 a[100:103], v37 offset:18432
    buffer_load_dwordx4 v32, s[20:23], s58 offen  lds
    ds_read_b128 a[104:107], v37 offset:20480
    ds_read_b128 a[108:111], v37 offset:22528
    s_waitcnt vmcnt(10)
    s_waitcnt lgkmcnt(0)
    s_barrier
    v_mfma_f32_16x16x32_bf16 v[80:83], a[0:3], a[16:19], 0
    v_add_u32 v36, 73728, v34
    v_xor_b32 v37, 0x40, v36
    v_mfma_f32_16x16x32_bf16 v[104:107], a[4:7], a[16:19], 0
    v_add_u32 v38, 98304, v24
    v_add_u32 v39, 98304, v25
    v_mfma_f32_16x16x32_bf16 v[84:87], a[0:3], a[20:23], 0
    ds_read_b64_tr_b16 a[112:113], v38 offset:0
    s_add_u32 s74, s83, 3
    v_mfma_f32_16x16x32_bf16 v[108:111], a[4:7], a[20:23], 0
    ds_read_b64_tr_b16 a[114:115], v38 offset:4096
    s_and_b32 s74, s74, 7
    v_mfma_f32_16x16x32_bf16 v[88:91], a[0:3], a[24:27], 0
    ds_read_b64_tr_b16 a[116:117], v39 offset:0
    s_lshl_b32 s59, s74, 19
    v_mfma_f32_16x16x32_bf16 v[112:115], a[4:7], a[24:27], 0
    ds_read_b64_tr_b16 a[118:119], v39 offset:4096
    s_add_u32 s59, s59, s64
    v_mfma_f32_16x16x32_bf16 v[92:95], a[0:3], a[28:31], 0
    ds_read_b128 a[128:131], v36 offset:0
    s_add_u32 m0, s76, 57344
    v_mfma_f32_16x16x32_bf16 v[116:119], a[4:7], a[28:31], 0
    ds_read_b128 a[132:135], v36 offset:2048
    s_add_u32 s58, s59, 0
    v_mfma_f32_16x16x32_bf16 v[96:99], a[0:3], a[32:35], 0
    ds_read_b128 a[136:139], v36 offset:4096
    buffer_load_dwordx4 v20, s[32:35], s58 offen  lds
    v_mfma_f32_16x16x32_bf16 v[120:123], a[4:7], a[32:35], 0
    ds_read_b128 a[140:143], v36 offset:6144
    s_add_u32 m0, s76, 58368
    v_mfma_f32_16x16x32_bf16 v[100:103], a[0:3], a[36:39], 0
    ds_read_b128 a[144:147], v36 offset:8192
    s_add_u32 s58, s59, 65536
    v_mfma_f32_16x16x32_bf16 v[124:127], a[4:7], a[36:39], 0
    ds_read_b128 a[148:151], v36 offset:10240
    v_mfma_f32_16x16x32_bf16 v[128:131], a[0:3], a[64:67], 0
    ds_read_b128 a[176:179], v36 offset:12288
    buffer_load_dwordx4 v21, s[32:35], s58 offen  lds
    v_mfma_f32_16x16x32_bf16 v[152:155], a[4:7], a[64:67], 0
    ds_read_b128 a[180:183], v36 offset:14336
    s_add_u32 m0, s76, 59392
    v_mfma_f32_16x16x32_bf16 v[132:135], a[0:3], a[68:71], 0
    ds_read_b128 a[184:187], v36 offset:16384
    s_add_u32 s58, s59, 131072
    v_mfma_f32_16x16x32_bf16 v[156:159], a[4:7], a[68:71], 0
    ds_read_b128 a[188:191], v36 offset:18432
    v_mfma_f32_16x16x32_bf16 v[136:139], a[0:3], a[72:75], 0
    ds_read_b128 a[192:195], v36 offset:20480
    buffer_load_dwordx4 v20, s[32:35], s58 offen  lds
    v_mfma_f32_16x16x32_bf16 v[160:163], a[4:7], a[72:75], 0
    ds_read_b128 a[196:199], v36 offset:22528
    s_add_u32 m0, s76, 60416
    v_mfma_f32_16x16x32_bf16 v[140:143], a[0:3], a[76:79], 0
    ds_read_b64_tr_b16 a[120:121], v38 offset:8192
    s_add_u32 s58, s59, 196608
    v_mfma_f32_16x16x32_bf16 v[164:167], a[4:7], a[76:79], 0
    ds_read_b64_tr_b16 a[122:123], v38 offset:12288
    s_lshl_b32 s59, s74, 7
    v_mfma_f32_16x16x32_bf16 v[144:147], a[0:3], a[80:83], 0
    ds_read_b64_tr_b16 a[124:125], v39 offset:8192
    buffer_load_dwordx4 v21, s[32:35], s58 offen  lds
    v_mfma_f32_16x16x32_bf16 v[168:171], a[4:7], a[80:83], 0
    ds_read_b64_tr_b16 a[126:127], v39 offset:12288
    s_add_u32 s59, s59, s61
    v_mfma_f32_16x16x32_bf16 v[148:151], a[0:3], a[84:87], 0
    ds_read_b128 a[152:155], v37 offset:0
    s_add_u32 m0, s75, 32768
    v_mfma_f32_16x16x32_bf16 v[172:175], a[4:7], a[84:87], 0
    ds_read_b128 a[156:159], v37 offset:2048
    s_add_u32 s58, s59, 0
    v_mfma_f32_16x16x32_bf16 v[80:83], a[8:11], a[40:43], v[80:83]
    ds_read_b128 a[160:163], v37 offset:4096
    buffer_load_dwordx4 v32, s[20:23], s58 offen  lds
    v_mfma_f32_16x16x32_bf16 v[104:107], a[12:15], a[40:43], v[104:107]
    ds_read_b128 a[164:167], v37 offset:6144
    s_add_u32 m0, s75, 33792
    v_mfma_f32_16x16x32_bf16 v[84:87], a[8:11], a[44:47], v[84:87]
    ds_read_b128 a[168:171], v37 offset:8192
    s_add_u32 s58, s59, 8192
    v_mfma_f32_16x16x32_bf16 v[108:111], a[12:15], a[44:47], v[108:111]
    ds_read_b128 a[172:175], v37 offset:10240
    v_mfma_f32_16x16x32_bf16 v[88:91], a[8:11], a[48:51], v[88:91]
    ds_read_b128 a[200:203], v37 offset:12288
    buffer_load_dwordx4 v33, s[20:23], s58 offen  lds
    v_mfma_f32_16x16x32_bf16 v[112:115], a[12:15], a[48:51], v[112:115]
    ds_read_b128 a[204:207], v37 offset:14336
    s_add_u32 m0, s75, 34816
    v_mfma_f32_16x16x32_bf16 v[92:95], a[8:11], a[52:55], v[92:95]
    ds_read_b128 a[208:211], v37 offset:16384
    s_add_u32 s58, s59, 16384
    v_mfma_f32_16x16x32_bf16 v[116:119], a[12:15], a[52:55], v[116:119]
    ds_read_b128 a[212:215], v37 offset:18432
    v_mfma_f32_16x16x32_bf16 v[96:99], a[8:11], a[56:59], v[96:99]
    ds_read_b128 a[216:219], v37 offset:20480
    buffer_load_dwordx4 v32, s[20:23], s58 offen  lds
    v_mfma_f32_16x16x32_bf16 v[120:123], a[12:15], a[56:59], v[120:123]
    ds_read_b128 a[220:223], v37 offset:22528
    s_add_u32 m0, s75, 45056
    v_mfma_f32_16x16x32_bf16 v[100:103], a[8:11], a[60:63], v[100:103]
    s_add_u32 s58, s59, 786432
    v_mfma_f32_16x16x32_bf16 v[124:127], a[12:15], a[60:63], v[124:127]
    v_mfma_f32_16x16x32_bf16 v[128:131], a[8:11], a[88:91], v[128:131]
    buffer_load_dwordx4 v32, s[20:23], s58 offen  lds
    v_mfma_f32_16x16x32_bf16 v[152:155], a[12:15], a[88:91], v[152:155]
    s_add_u32 m0, s75, 46080
    s_add_u32 s58, s59, 794624
    v_mfma_f32_16x16x32_bf16 v[132:135], a[8:11], a[92:95], v[132:135]
    v_mfma_f32_16x16x32_bf16 v[156:159], a[12:15], a[92:95], v[156:159]
    v_mfma_f32_16x16x32_bf16 v[136:139], a[8:11], a[96:99], v[136:139]
    buffer_load_dwordx4 v33, s[20:23], s58 offen  lds
    v_mfma_f32_16x16x32_bf16 v[160:163], a[12:15], a[96:99], v[160:163]
    s_add_u32 m0, s75, 47104
    s_add_u32 s58, s59, 802816
    v_mfma_f32_16x16x32_bf16 v[140:143], a[8:11], a[100:103], v[140:143]
    v_mfma_f32_16x16x32_bf16 v[164:167], a[12:15], a[100:103], v[164:167]
    v_mfma_f32_16x16x32_bf16 v[144:147], a[8:11], a[104:107], v[144:147]
    buffer_load_dwordx4 v32, s[20:23], s58 offen  lds
    v_mfma_f32_16x16x32_bf16 v[168:171], a[12:15], a[104:107], v[168:171]
    v_mfma_f32_16x16x32_bf16 v[148:151], a[8:11], a[108:111], v[148:151]
    v_mfma_f32_16x16x32_bf16 v[172:175], a[12:15], a[108:111], v[172:175]
    s_waitcnt vmcnt(10)
    s_waitcnt lgkmcnt(0)
    s_barrier
    v_mfma_f32_16x16x32_bf16 v[80:83], a[112:115], a[128:131], v[80:83]
    v_add_u32 v36, 114688, v34
    v_xor_b32 v37, 0x40, v36
    v_mfma_f32_16x16x32_bf16 v[104:107], a[116:119], a[128:131], v[104:107]
    v_add_u32 v38, 139264, v24
    v_add_u32 v39, 139264, v25
    v_mfma_f32_16x16x32_bf16 v[84:87], a[112:115], a[132:135], v[84:87]
    ds_read_b64_tr_b16 a[0:1], v38 offset:0
    s_add_u32 s74, s83, 4
    v_mfma_f32_16x16x32_bf16 v[108:111], a[116:119], a[132:135], v[108:111]
    ds_read_b64_tr_b16 a[2:3], v38 offset:4096
    s_and_b32 s74, s74, 7
    v_mfma_f32_16x16x32_bf16 v[88:91], a[112:115], a[136:139], v[88:91]
    ds_read_b64_tr_b16 a[4:5], v39 offset:0
    s_lshl_b32 s59, s74, 19
    v_mfma_f32_16x16x32_bf16 v[112:115], a[116:119], a[136:139], v[112:115]
    ds_read_b64_tr_b16 a[6:7], v39 offset:4096
    s_add_u32 s59, s59, s64
    v_mfma_f32_16x16x32_bf16 v[92:95], a[112:115], a[140:143], v[92:95]
    ds_read_b128 a[16:19], v36 offset:0
    s_add_u32 m0, s76, 98304
    v_mfma_f32_16x16x32_bf16 v[116:119], a[116:119], a[140:143], v[116:119]
    ds_read_b128 a[20:23], v36 offset:2048
    s_add_u32 s58, s59, 0
    v_mfma_f32_16x16x32_bf16 v[96:99], a[112:115], a[144:147], v[96:99]
    ds_read_b128 a[24:27], v36 offset:4096
    buffer_load_dwordx4 v20, s[32:35], s58 offen  lds
    v_mfma_f32_16x16x32_bf16 v[120:123], a[116:119], a[144:147], v[120:123]
    ds_read_b128 a[28:31], v36 offset:6144
    s_add_u32 m0, s76, 99328
    v_mfma_f32_16x16x32_bf16 v[100:103], a[112:115], a[148:151], v[100:103]
    ds_read_b128 a[32:35], v36 offset:8192
    s_add_u32 s58, s59, 65536
    v_mfma_f32_16x16x32_bf16 v[124:127], a[116:119], a[148:151], v[124:127]
    ds_read_b128 a[36:39], v36 offset:10240
    v_mfma_f32_16x16x32_bf16 v[128:131], a[112:115], a[176:179], v[128:131]
    ds_read_b128 a[64:67], v36 offset:12288
    buffer_load_dwordx4 v21, s[32:35], s58 offen  lds
    v_mfma_f32_16x16x32_bf16 v[152:155], a[116:119], a[176:179], v[152:155]
    ds_read_b128 a[68:71], v36 offset:14336
    s_add_u32 m0, s76, 100352
    v_mfma_f32_16x16x32_bf16 v[132:135], a[112:115], a[180:183], v[132:135]
    ds_read_b128 a[72:75], v36 offset:16384
    s_add_u32 s58, s59, 131072
    v_mfma_f32_16x16x32_bf16 v[156:159], a[116:119], a[180:183], v[156:159]
    ds_read_b128 a[76:79], v36 offset:18432
    v_mfma_f32_16x16x32_bf16 v[136:139], a[112:115], a[184:187], v[136:139]
    ds_read_b128 a[80:83], v36 offset:20480
    buffer_load_dwordx4 v20, s[32:35], s58 offen  lds
    v_mfma_f32_16x16x32_bf16 v[160:163], a[116:119], a[184:187], v[160:163]
    ds_read_b128 a[84:87], v36 offset:22528
    s_add_u32 m0, s76, 101376
    v_mfma_f32_16x16x32_bf16 v[140:143], a[112:115], a[188:191], v[140:143]
    ds_read_b64_tr_b16 a[8:9], v38 offset:8192
    s_add_u32 s58, s59, 196608
    v_mfma_f32_16x16x32_bf16 v[164:167], a[116:119], a[188:191], v[164:167]
    ds_read_b64_tr_b16 a[10:11], v38 offset:12288
    s_lshl_b32 s59, s74, 7
    v_mfma_f32_16x16x32_bf16 v[144:147], a[112:115], a[192:195], v[144:147]
    ds_read_b64_tr_b16 a[12:13], v39 offset:8192
    buffer_load_dwordx4 v21, s[32:35], s58 offen  lds
    v_mfma_f32_16x16x32_bf16 v[168:171], a[116:119], a[192:195], v[168:171]
    ds_read_b64_tr_b16 a[14:15], v39 offset:12288
    s_add_u32 s59, s59, s61
    v_mfma_f32_16x16x32_bf16 v[148:151], a[112:115], a[196:199], v[148:151]
    ds_read_b128 a[40:43], v37 offset:0
    s_add_u32 m0, s75, 73728
    v_mfma_f32_16x16x32_bf16 v[172:175], a[116:119], a[196:199], v[172:175]
    ds_read_b128 a[44:47], v37 offset:2048
    s_add_u32 s58, s59, 0
    v_mfma_f32_16x16x32_bf16 v[80:83], a[120:123], a[152:155], v[80:83]
    ds_read_b128 a[48:51], v37 offset:4096
    buffer_load_dwordx4 v32, s[20:23], s58 offen  lds
    v_mfma_f32_16x16x32_bf16 v[104:107], a[124:127], a[152:155], v[104:107]
    ds_read_b128 a[52:55], v37 offset:6144
    s_add_u32 m0, s75, 74752
    v_mfma_f32_16x16x32_bf16 v[84:87], a[120:123], a[156:159], v[84:87]
    ds_read_b128 a[56:59], v37 offset:8192
    s_add_u32 s58, s59, 8192
    v_mfma_f32_16x16x32_bf16 v[108:111], a[124:127], a[156:159], v[108:111]
    ds_read_b128 a[60:63], v37 offset:10240
    v_mfma_f32_16x16x32_bf16 v[88:91], a[120:123], a[160:163], v[88:91]
    ds_read_b128 a[88:91], v37 offset:12288
    buffer_load_dwordx4 v33, s[20:23], s58 offen  lds
    v_mfma_f32_16x16x32_bf16 v[112:115], a[124:127], a[160:163], v[112:115]
    ds_read_b128 a[92:95], v37 offset:14336
    s_add_u32 m0, s75, 75776
    v_mfma_f32_16x16x32_bf16 v[92:95], a[120:123], a[164:167], v[92:95]
    ds_read_b128 a[96:99], v37 offset:16384
    s_add_u32 s58, s59, 16384
    v_mfma_f32_16x16x32_bf16 v[116:119], a[124:127], a[164:167], v[116:119]
    ds_read_b128 a[100:103], v37 offset:18432
    v_mfma_f32_16x16x32_bf16 v[96:99], a[120:123], a[168:171], v[96:99]
    ds_read_b128 a[104:107], v37 offset:20480
    buffer_load_dwordx4 v32, s[20:23], s58 offen  lds
    v_mfma_f32_16x16x32_bf16 v[120:123], a[124:127], a[168:171], v[120:123]
    ds_read_b128 a[108:111], v37 offset:22528
    s_add_u32 m0, s75, 86016
    v_mfma_f32_16x16x32_bf16 v[100:103], a[120:123], a[172:175], v[100:103]
    s_add_u32 s58, s59, 786432
    v_mfma_f32_16x16x32_bf16 v[124:127], a[124:127], a[172:175], v[124:127]
    v_mfma_f32_16x16x32_bf16 v[128:131], a[120:123], a[200:203], v[128:131]
    buffer_load_dwordx4 v32, s[20:23], s58 offen  lds
    v_mfma_f32_16x16x32_bf16 v[152:155], a[124:127], a[200:203], v[152:155]
    s_add_u32 m0, s75, 87040
    s_add_u32 s58, s59, 794624
    v_mfma_f32_16x16x32_bf16 v[132:135], a[120:123], a[204:207], v[132:135]
    v_mfma_f32_16x16x32_bf16 v[156:159], a[124:127], a[204:207], v[156:159]
    v_mfma_f32_16x16x32_bf16 v[136:139], a[120:123], a[208:211], v[136:139]
    buffer_load_dwordx4 v33, s[20:23], s58 offen  lds
    v_mfma_f32_16x16x32_bf16 v[160:163], a[124:127], a[208:211], v[160:163]
    s_add_u32 m0, s75, 88064
    s_add_u32 s58, s59, 802816
    v_mfma_f32_16x16x32_bf16 v[140:143], a[120:123], a[212:215], v[140:143]
    v_mfma_f32_16x16x32_bf16 v[164:167], a[124:127], a[212:215], v[164:167]
    v_mfma_f32_16x16x32_bf16 v[144:147], a[120:123], a[216:219], v[144:147]
    buffer_load_dwordx4 v32, s[20:23], s58 offen  lds
    v_mfma_f32_16x16x32_bf16 v[168:171], a[124:127], a[216:219], v[168:171]
    v_mfma_f32_16x16x32_bf16 v[148:151], a[120:123], a[220:223], v[148:151]
    v_mfma_f32_16x16x32_bf16 v[172:175], a[124:127], a[220:223], v[172:175]
    s_waitcnt vmcnt(10)
    s_waitcnt lgkmcnt(0)
    s_barrier
    v_mfma_f32_16x16x32_bf16 v[80:83], a[0:3], a[16:19], v[80:83]
    v_add_u32 v36, 32768, v34
    v_xor_b32 v37, 0x40, v36
    v_mfma_f32_16x16x32_bf16 v[104:107], a[4:7], a[16:19], v[104:107]
    v_add_u32 v38, 57344, v24
    v_add_u32 v39, 57344, v25
    v_mfma_f32_16x16x32_bf16 v[84:87], a[0:3], a[20:23], v[84:87]
    ds_read_b64_tr_b16 a[112:113], v38 offset:0
    s_add_u32 s74, s83, 5
    v_mfma_f32_16x16x32_bf16 v[108:111], a[4:7], a[20:23], v[108:111]
    ds_read_b64_tr_b16 a[114:115], v38 offset:4096
    s_and_b32 s74, s74, 7
    v_mfma_f32_16x16x32_bf16 v[88:91], a[0:3], a[24:27], v[88:91]
    ds_read_b64_tr_b16 a[116:117], v39 offset:0
    s_lshl_b32 s59, s74, 19
    v_mfma_f32_16x16x32_bf16 v[112:115], a[4:7], a[24:27], v[112:115]
    ds_read_b64_tr_b16 a[118:119], v39 offset:4096
    s_add_u32 s59, s59, s64
    v_mfma_f32_16x16x32_bf16 v[92:95], a[0:3], a[28:31], v[92:95]
    ds_read_b128 a[128:131], v36 offset:0
    s_add_u32 m0, s76, 139264
    v_mfma_f32_16x16x32_bf16 v[116:119], a[4:7], a[28:31], v[116:119]
    ds_read_b128 a[132:135], v36 offset:2048
    s_add_u32 s58, s59, 0
    v_mfma_f32_16x16x32_bf16 v[96:99], a[0:3], a[32:35], v[96:99]
    ds_read_b128 a[136:139], v36 offset:4096
    buffer_load_dwordx4 v20, s[32:35], s58 offen  lds
    v_mfma_f32_16x16x32_bf16 v[120:123], a[4:7], a[32:35], v[120:123]
    ds_read_b128 a[140:143], v36 offset:6144
    s_add_u32 m0, s76, 140288
    v_mfma_f32_16x16x32_bf16 v[100:103], a[0:3], a[36:39], v[100:103]
    ds_read_b128 a[144:147], v36 offset:8192
    s_add_u32 s58, s59, 65536
    v_mfma_f32_16x16x32_bf16 v[124:127], a[4:7], a[36:39], v[124:127]
    ds_read_b128 a[148:151], v36 offset:10240
    v_mfma_f32_16x16x32_bf16 v[128:131], a[0:3], a[64:67], v[128:131]
    ds_read_b128 a[176:179], v36 offset:12288
    buffer_load_dwordx4 v21, s[32:35], s58 offen  lds
    v_mfma_f32_16x16x32_bf16 v[152:155], a[4:7], a[64:67], v[152:155]
    ds_read_b128 a[180:183], v36 offset:14336
    s_add_u32 m0, s76, 141312
    v_mfma_f32_16x16x32_bf16 v[132:135], a[0:3], a[68:71], v[132:135]
    ds_read_b128 a[184:187], v36 offset:16384
    s_add_u32 s58, s59, 131072
    v_mfma_f32_16x16x32_bf16 v[156:159], a[4:7], a[68:71], v[156:159]
    ds_read_b128 a[188:191], v36 offset:18432
    v_mfma_f32_16x16x32_bf16 v[136:139], a[0:3], a[72:75], v[136:139]
    ds_read_b128 a[192:195], v36 offset:20480
    buffer_load_dwordx4 v20, s[32:35], s58 offen  lds
    v_mfma_f32_16x16x32_bf16 v[160:163], a[4:7], a[72:75], v[160:163]
    ds_read_b128 a[196:199], v36 offset:22528
    s_add_u32 m0, s76, 142336
    v_mfma_f32_16x16x32_bf16 v[140:143], a[0:3], a[76:79], v[140:143]
    ds_read_b64_tr_b16 a[120:121], v38 offset:8192
    s_add_u32 s58, s59, 196608
    v_mfma_f32_16x16x32_bf16 v[164:167], a[4:7], a[76:79], v[164:167]
    ds_read_b64_tr_b16 a[122:123], v38 offset:12288
    s_lshl_b32 s59, s74, 7
    v_mfma_f32_16x16x32_bf16 v[144:147], a[0:3], a[80:83], v[144:147]
    ds_read_b64_tr_b16 a[124:125], v39 offset:8192
    buffer_load_dwordx4 v21, s[32:35], s58 offen  lds
    v_mfma_f32_16x16x32_bf16 v[168:171], a[4:7], a[80:83], v[168:171]
    ds_read_b64_tr_b16 a[126:127], v39 offset:12288
    s_add_u32 s59, s59, s61
    v_mfma_f32_16x16x32_bf16 v[148:151], a[0:3], a[84:87], v[148:151]
    ds_read_b128 a[152:155], v37 offset:0
    s_add_u32 m0, s75, 114688
    v_mfma_f32_16x16x32_bf16 v[172:175], a[4:7], a[84:87], v[172:175]
    ds_read_b128 a[156:159], v37 offset:2048
    s_add_u32 s58, s59, 0
    v_mfma_f32_16x16x32_bf16 v[80:83], a[8:11], a[40:43], v[80:83]
    ds_read_b128 a[160:163], v37 offset:4096
    buffer_load_dwordx4 v32, s[20:23], s58 offen  lds
    v_mfma_f32_16x16x32_bf16 v[104:107], a[12:15], a[40:43], v[104:107]
    ds_read_b128 a[164:167], v37 offset:6144
    s_add_u32 m0, s75, 115712
    v_mfma_f32_16x16x32_bf16 v[84:87], a[8:11], a[44:47], v[84:87]
    ds_read_b128 a[168:171], v37 offset:8192
    s_add_u32 s58, s59, 8192
    v_mfma_f32_16x16x32_bf16 v[108:111], a[12:15], a[44:47], v[108:111]
    ds_read_b128 a[172:175], v37 offset:10240
    v_mfma_f32_16x16x32_bf16 v[88:91], a[8:11], a[48:51], v[88:91]
    ds_read_b128 a[200:203], v37 offset:12288
    buffer_load_dwordx4 v33, s[20:23], s58 offen  lds
    v_mfma_f32_16x16x32_bf16 v[112:115], a[12:15], a[48:51], v[112:115]
    ds_read_b128 a[204:207], v37 offset:14336
    s_add_u32 m0, s75, 116736
    v_mfma_f32_16x16x32_bf16 v[92:95], a[8:11], a[52:55], v[92:95]
    ds_read_b128 a[208:211], v37 offset:16384
    s_add_u32 s58, s59, 16384
    v_mfma_f32_16x16x32_bf16 v[116:119], a[12:15], a[52:55], v[116:119]
    ds_read_b128 a[212:215], v37 offset:18432
    v_mfma_f32_16x16x32_bf16 v[96:99], a[8:11], a[56:59], v[96:99]
    ds_read_b128 a[216:219], v37 offset:20480
    buffer_load_dwordx4 v32, s[20:23], s58 offen  lds
    v_mfma_f32_16x16x32_bf16 v[120:123], a[12:15], a[56:59], v[120:123]
    ds_read_b128 a[220:223], v37 offset:22528
    s_add_u32 m0, s75, 126976
    v_mfma_f32_16x16x32_bf16 v[100:103], a[8:11], a[60:63], v[100:103]
    s_add_u32 s58, s59, 786432
    v_mfma_f32_16x16x32_bf16 v[124:127], a[12:15], a[60:63], v[124:127]
    v_mfma_f32_16x16x32_bf16 v[128:131], a[8:11], a[88:91], v[128:131]
    buffer_load_dwordx4 v32, s[20:23], s58 offen  lds
    v_mfma_f32_16x16x32_bf16 v[152:155], a[12:15], a[88:91], v[152:155]
    s_add_u32 m0, s75, 128000
    s_add_u32 s58, s59, 794624
    v_mfma_f32_16x16x32_bf16 v[132:135], a[8:11], a[92:95], v[132:135]
    v_mfma_f32_16x16x32_bf16 v[156:159], a[12:15], a[92:95], v[156:159]
    v_mfma_f32_16x16x32_bf16 v[136:139], a[8:11], a[96:99], v[136:139]
    buffer_load_dwordx4 v33, s[20:23], s58 offen  lds
    v_mfma_f32_16x16x32_bf16 v[160:163], a[12:15], a[96:99], v[160:163]
    s_add_u32 m0, s75, 129024
    s_add_u32 s58, s59, 802816
    v_mfma_f32_16x16x32_bf16 v[140:143], a[8:11], a[100:103], v[140:143]
    v_mfma_f32_16x16x32_bf16 v[164:167], a[12:15], a[100:103], v[164:167]
    v_mfma_f32_16x16x32_bf16 v[144:147], a[8:11], a[104:107], v[144:147]
    buffer_load_dwordx4 v32, s[20:23], s58 offen  lds
    v_mfma_f32_16x16x32_bf16 v[168:171], a[12:15], a[104:107], v[168:171]
    s_mov_b32 m0, s55
    v_mfma_f32_16x16x32_bf16 v[148:151], a[8:11], a[108:111], v[148:151]
    v_mfma_f32_16x16x32_bf16 v[172:175], a[12:15], a[108:111], v[172:175]
    buffer_load_dwordx4 v2, s[24:27], s54 offen offset:0 nt lds
    buffer_load_dwordx4 v3, s[24:27], s54 offen offset:1024 nt lds
    buffer_load_dwordx4 v4, s[24:27], s54 offen offset:2048 nt lds
    buffer_load_dwordx4 v5, s[24:27], s54 offen offset:3072 nt lds
    s_add_u32 s54, s54, 16384
    s_add_u32 s55, s55, 32768
    s_cmp_ge_u32 s55, 98304
    s_cselect_b32 s60, 98304, 0
    s_sub_u32 s55, s55, s60
    s_waitcnt vmcnt(14)
    s_waitcnt lgkmcnt(0)
    s_barrier
    v_mfma_f32_16x16x32_bf16 v[80:83], a[112:115], a[128:131], v[80:83]
    v_add_u32 v36, 73728, v34
    v_xor_b32 v37, 0x40, v36
    v_mfma_f32_16x16x32_bf16 v[104:107], a[116:119], a[128:131], v[104:107]
    v_add_u32 v38, 98304, v24
    v_add_u32 v39, 98304, v25
    v_mfma_f32_16x16x32_bf16 v[84:87], a[112:115], a[132:135], v[84:87]
    ds_read_b64_tr_b16 a[0:1], v38 offset:0
    s_add_u32 s74, s83, 6
    v_mfma_f32_16x16x32_bf16 v[108:111], a[116:119], a[132:135], v[108:111]
    ds_read_b64_tr_b16 a[2:3], v38 offset:4096
    s_and_b32 s74, s74, 7
    v_mfma_f32_16x16x32_bf16 v[88:91], a[112:115], a[136:139], v[88:91]
    ds_read_b64_tr_b16 a[4:5], v39 offset:0
    s_lshl_b32 s59, s74, 19
    v_mfma_f32_16x16x32_bf16 v[112:115], a[116:119], a[136:139], v[112:115]
    ds_read_b64_tr_b16 a[6:7], v39 offset:4096
    s_add_u32 s59, s59, s64
    v_mfma_f32_16x16x32_bf16 v[92:95], a[112:115], a[140:143], v[92:95]
    ds_read_b128 a[16:19], v36 offset:0
    s_add_u32 m0, s76, 57344
    v_mfma_f32_16x16x32_bf16 v[116:119], a[116:119], a[140:143], v[116:119]
    ds_read_b128 a[20:23], v36 offset:2048
    s_add_u32 s58, s59, 0
    v_mfma_f32_16x16x32_bf16 v[96:99], a[112:115], a[144:147], v[96:99]
    ds_read_b128 a[24:27], v36 offset:4096
    buffer_load_dwordx4 v20, s[32:35], s58 offen  lds
    v_mfma_f32_16x16x32_bf16 v[120:123], a[116:119], a[144:147], v[120:123]
    ds_read_b128 a[28:31], v36 offset:6144
    s_add_u32 m0, s76, 58368
    v_mfma_f32_16x16x32_bf16 v[100:103], a[112:115], a[148:151], v[100:103]
    ds_read_b128 a[32:35], v36 offset:8192
    s_add_u32 s58, s59, 65536
    v_mfma_f32_16x16x32_bf16 v[124:127], a[116:119], a[148:151], v[124:127]
    ds_read_b128 a[36:39], v36 offset:10240
    v_mfma_f32_16x16x32_bf16 v[128:131], a[112:115], a[176:179], v[128:131]
    ds_read_b128 a[64:67], v36 offset:12288
    buffer_load_dwordx4 v21, s[32:35], s58 offen  lds
    v_mfma_f32_16x16x32_bf16 v[152:155], a[116:119], a[176:179], v[152:155]
    ds_read_b128 a[68:71], v36 offset:14336
    s_add_u32 m0, s76, 59392
    v_mfma_f32_16x16x32_bf16 v[132:135], a[112:115], a[180:183], v[132:135]
    ds_read_b128 a[72:75], v36 offset:16384
    s_add_u32 s58, s59, 131072
    v_mfma_f32_16x16x32_bf16 v[156:159], a[116:119], a[180:183], v[156:159]
    ds_read_b128 a[76:79], v36 offset:18432
    v_mfma_f32_16x16x32_bf16 v[136:139], a[112:115], a[184:187], v[136:139]
    ds_read_b128 a[80:83], v36 offset:20480
    buffer_load_dwordx4 v20, s[32:35], s58 offen  lds
    v_mfma_f32_16x16x32_bf16 v[160:163], a[116:119], a[184:187], v[160:163]
    ds_read_b128 a[84:87], v36 offset:22528
    s_add_u32 m0, s76, 60416
    v_mfma_f32_16x16x32_bf16 v[140:143], a[112:115], a[188:191], v[140:143]
    ds_read_b64_tr_b16 a[8:9], v38 offset:8192
    s_add_u32 s58, s59, 196608
    v_mfma_f32_16x16x32_bf16 v[164:167], a[116:119], a[188:191], v[164:167]
    ds_read_b64_tr_b16 a[10:11], v38 offset:12288
    s_lshl_b32 s59, s74, 7
    v_mfma_f32_16x16x32_bf16 v[144:147], a[112:115], a[192:195], v[144:147]
    ds_read_b64_tr_b16 a[12:13], v39 offset:8192
    buffer_load_dwordx4 v21, s[32:35], s58 offen  lds
    v_mfma_f32_16x16x32_bf16 v[168:171], a[116:119], a[192:195], v[168:171]
    ds_read_b64_tr_b16 a[14:15], v39 offset:12288
    s_add_u32 s59, s59, s61
    v_mfma_f32_16x16x32_bf16 v[148:151], a[112:115], a[196:199], v[148:151]
    ds_read_b128 a[40:43], v37 offset:0
    s_add_u32 m0, s75, 32768
    v_mfma_f32_16x16x32_bf16 v[172:175], a[116:119], a[196:199], v[172:175]
    ds_read_b128 a[44:47], v37 offset:2048
    s_add_u32 s58, s59, 0
    v_mfma_f32_16x16x32_bf16 v[80:83], a[120:123], a[152:155], v[80:83]
    ds_read_b128 a[48:51], v37 offset:4096
    buffer_load_dwordx4 v32, s[20:23], s58 offen  lds
    v_mfma_f32_16x16x32_bf16 v[104:107], a[124:127], a[152:155], v[104:107]
    ds_read_b128 a[52:55], v37 offset:6144
    s_add_u32 m0, s75, 33792
    v_mfma_f32_16x16x32_bf16 v[84:87], a[120:123], a[156:159], v[84:87]
    ds_read_b128 a[56:59], v37 offset:8192
    s_add_u32 s58, s59, 8192
    v_mfma_f32_16x16x32_bf16 v[108:111], a[124:127], a[156:159], v[108:111]
    ds_read_b128 a[60:63], v37 offset:10240
    v_mfma_f32_16x16x32_bf16 v[88:91], a[120:123], a[160:163], v[88:91]
    ds_read_b128 a[88:91], v37 offset:12288
    buffer_load_dwordx4 v33, s[20:23], s58 offen  lds
    v_mfma_f32_16x16x32_bf16 v[112:115], a[124:127], a[160:163], v[112:115]
    ds_read_b128 a[92:95], v37 offset:14336
    s_add_u32 m0, s75, 34816
    v_mfma_f32_16x16x32_bf16 v[92:95], a[120:123], a[164:167], v[92:95]
    ds_read_b128 a[96:99], v37 offset:16384
    s_add_u32 s58, s59, 16384
    v_mfma_f32_16x16x32_bf16 v[116:119], a[124:127], a[164:167], v[116:119]
    ds_read_b128 a[100:103], v37 offset:18432
    v_mfma_f32_16x16x32_bf16 v[96:99], a[120:123], a[168:171], v[96:99]
    ds_read_b128 a[104:107], v37 offset:20480
    buffer_load_dwordx4 v32, s[20:23], s58 offen  lds
    v_mfma_f32_16x16x32_bf16 v[120:123], a[124:127], a[168:171], v[120:123]
    ds_read_b128 a[108:111], v37 offset:22528
    s_add_u32 m0, s75, 45056
    v_mfma_f32_16x16x32_bf16 v[100:103], a[120:123], a[172:175], v[100:103]
    s_add_u32 s58, s59, 786432
    v_mfma_f32_16x16x32_bf16 v[124:127], a[124:127], a[172:175], v[124:127]
    v_mfma_f32_16x16x32_bf16 v[128:131], a[120:123], a[200:203], v[128:131]
    buffer_load_dwordx4 v32, s[20:23], s58 offen  lds
    v_mfma_f32_16x16x32_bf16 v[152:155], a[124:127], a[200:203], v[152:155]
    s_add_u32 m0, s75, 46080
    s_add_u32 s58, s59, 794624
    v_mfma_f32_16x16x32_bf16 v[132:135], a[120:123], a[204:207], v[132:135]
    v_mfma_f32_16x16x32_bf16 v[156:159], a[124:127], a[204:207], v[156:159]
    v_mfma_f32_16x16x32_bf16 v[136:139], a[120:123], a[208:211], v[136:139]
    buffer_load_dwordx4 v33, s[20:23], s58 offen  lds
    v_mfma_f32_16x16x32_bf16 v[160:163], a[124:127], a[208:211], v[160:163]
    s_add_u32 m0, s75, 47104
    s_add_u32 s58, s59, 802816
    v_mfma_f32_16x16x32_bf16 v[140:143], a[120:123], a[212:215], v[140:143]
    v_mfma_f32_16x16x32_bf16 v[164:167], a[124:127], a[212:215], v[164:167]
    v_mfma_f32_16x16x32_bf16 v[144:147], a[120:123], a[216:219], v[144:147]
    buffer_load_dwordx4 v32, s[20:23], s58 offen  lds
    v_mfma_f32_16x16x32_bf16 v[168:171], a[124:127], a[216:219], v[168:171]
    s_mov_b32 m0, s93
    v_mfma_f32_16x16x32_bf16 v[148:151], a[120:123], a[220:223], v[148:151]
    v_mfma_f32_16x16x32_bf16 v[172:175], a[124:127], a[220:223], v[172:175]
    buffer_load_dwordx4 v6, s[28:31], s92 offen offset:0 nt lds
    buffer_load_dwordx4 v7, s[28:31], s92 offen offset:1024 nt lds
    buffer_load_dwordx4 v6, s[28:31], s92 offen offset:2048 nt lds
    buffer_load_dwordx4 v7, s[28:31], s92 offen offset:3072 nt lds
    s_add_u32 s92, s92, 16384
    s_add_u32 s93, s93, 32768
    s_cmp_ge_u32 s93, 98304
    s_cselect_b32 s60, 98304, 0
    s_sub_u32 s93, s93, s60
    s_waitcnt vmcnt(18)
    s_waitcnt lgkmcnt(0)
    s_barrier
    v_mfma_f32_16x16x32_bf16 v[80:83], a[0:3], a[16:19], v[80:83]
    v_add_u32 v36, 114688, v34
    v_xor_b32 v37, 0x40, v36
    v_mfma_f32_16x16x32_bf16 v[104:107], a[4:7], a[16:19], v[104:107]
    v_add_u32 v38, 139264, v24
    v_add_u32 v39, 139264, v25
    v_mfma_f32_16x16x32_bf16 v[84:87], a[0:3], a[20:23], v[84:87]
    ds_read_b64_tr_b16 a[112:113], v38 offset:0
    s_add_u32 s74, s83, 7
    v_mfma_f32_16x16x32_bf16 v[108:111], a[4:7], a[20:23], v[108:111]
    ds_read_b64_tr_b16 a[114:115], v38 offset:4096
    s_and_b32 s74, s74, 7
    v_mfma_f32_16x16x32_bf16 v[88:91], a[0:3], a[24:27], v[88:91]
    ds_read_b64_tr_b16 a[116:117], v39 offset:0
    s_lshl_b32 s59, s74, 19
    v_mfma_f32_16x16x32_bf16 v[112:115], a[4:7], a[24:27], v[112:115]
    ds_read_b64_tr_b16 a[118:119], v39 offset:4096
    s_add_u32 s59, s59, s64
    v_mfma_f32_16x16x32_bf16 v[92:95], a[0:3], a[28:31], v[92:95]
    ds_read_b128 a[128:131], v36 offset:0
    s_add_u32 m0, s76, 98304
    v_mfma_f32_16x16x32_bf16 v[116:119], a[4:7], a[28:31], v[116:119]
    ds_read_b128 a[132:135], v36 offset:2048
    s_add_u32 s58, s59, 0
    v_mfma_f32_16x16x32_bf16 v[96:99], a[0:3], a[32:35], v[96:99]
    ds_read_b128 a[136:139], v36 offset:4096
    buffer_load_dwordx4 v20, s[32:35], s58 offen  lds
    v_mfma_f32_16x16x32_bf16 v[120:123], a[4:7], a[32:35], v[120:123]
    ds_read_b128 a[140:143], v36 offset:6144
    s_add_u32 m0, s76, 99328
    v_mfma_f32_16x16x32_bf16 v[100:103], a[0:3], a[36:39], v[100:103]
    ds_read_b128 a[144:147], v36 offset:8192
    s_add_u32 s58, s59, 65536
    v_mfma_f32_16x16x32_bf16 v[124:127], a[4:7], a[36:39], v[124:127]
    ds_read_b128 a[148:151], v36 offset:10240
    v_mfma_f32_16x16x32_bf16 v[128:131], a[0:3], a[64:67], v[128:131]
    ds_read_b128 a[176:179], v36 offset:12288
    buffer_load_dwordx4 v21, s[32:35], s58 offen  lds
    v_mfma_f32_16x16x32_bf16 v[152:155], a[4:7], a[64:67], v[152:155]
    ds_read_b128 a[180:183], v36 offset:14336
    s_add_u32 m0, s76, 100352
    v_mfma_f32_16x16x32_bf16 v[132:135], a[0:3], a[68:71], v[132:135]
    ds_read_b128 a[184:187], v36 offset:16384
    s_add_u32 s58, s59, 131072
    v_mfma_f32_16x16x32_bf16 v[156:159], a[4:7], a[68:71], v[156:159]
    ds_read_b128 a[188:191], v36 offset:18432
    v_mfma_f32_16x16x32_bf16 v[136:139], a[0:3], a[72:75], v[136:139]
    ds_read_b128 a[192:195], v36 offset:20480
    buffer_load_dwordx4 v20, s[32:35], s58 offen  lds
    v_mfma_f32_16x16x32_bf16 v[160:163], a[4:7], a[72:75], v[160:163]
    ds_read_b128 a[196:199], v36 offset:22528
    s_add_u32 m0, s76, 101376
    v_mfma_f32_16x16x32_bf16 v[140:143], a[0:3], a[76:79], v[140:143]
    ds_read_b64_tr_b16 a[120:121], v38 offset:8192
    s_add_u32 s58, s59, 196608
    v_mfma_f32_16x16x32_bf16 v[164:167], a[4:7], a[76:79], v[164:167]
    ds_read_b64_tr_b16 a[122:123], v38 offset:12288
    s_lshl_b32 s59, s74, 7
    v_mfma_f32_16x16x32_bf16 v[144:147], a[0:3], a[80:83], v[144:147]
    ds_read_b64_tr_b16 a[124:125], v39 offset:8192
    buffer_load_dwordx4 v21, s[32:35], s58 offen  lds
    v_mfma_f32_16x16x32_bf16 v[168:171], a[4:7], a[80:83], v[168:171]
    ds_read_b64_tr_b16 a[126:127], v39 offset:12288
    s_add_u32 s59, s59, s61
    v_mfma_f32_16x16x32_bf16 v[148:151], a[0:3], a[84:87], v[148:151]
    ds_read_b128 a[152:155], v37 offset:0
    s_add_u32 m0, s75, 73728
    v_mfma_f32_16x16x32_bf16 v[172:175], a[4:7], a[84:87], v[172:175]
    ds_read_b128 a[156:159], v37 offset:2048
    s_add_u32 s58, s59, 0
    v_mfma_f32_16x16x32_bf16 v[80:83], a[8:11], a[40:43], v[80:83]
    ds_read_b128 a[160:163], v37 offset:4096
    buffer_load_dwordx4 v32, s[20:23], s58 offen  lds
    v_mfma_f32_16x16x32_bf16 v[104:107], a[12:15], a[40:43], v[104:107]
    ds_read_b128 a[164:167], v37 offset:6144
    s_add_u32 m0, s75, 74752
    v_mfma_f32_16x16x32_bf16 v[84:87], a[8:11], a[44:47], v[84:87]
    ds_read_b128 a[168:171], v37 offset:8192
    s_add_u32 s58, s59, 8192
    v_mfma_f32_16x16x32_bf16 v[108:111], a[12:15], a[44:47], v[108:111]
    ds_read_b128 a[172:175], v37 offset:10240
    v_mfma_f32_16x16x32_bf16 v[88:91], a[8:11], a[48:51], v[88:91]
    ds_read_b128 a[200:203], v37 offset:12288
    buffer_load_dwordx4 v33, s[20:23], s58 offen  lds
    v_mfma_f32_16x16x32_bf16 v[112:115], a[12:15], a[48:51], v[112:115]
    ds_read_b128 a[204:207], v37 offset:14336
    s_add_u32 m0, s75, 75776
    v_mfma_f32_16x16x32_bf16 v[92:95], a[8:11], a[52:55], v[92:95]
    ds_read_b128 a[208:211], v37 offset:16384
    s_add_u32 s58, s59, 16384
    v_mfma_f32_16x16x32_bf16 v[116:119], a[12:15], a[52:55], v[116:119]
    ds_read_b128 a[212:215], v37 offset:18432
    v_mfma_f32_16x16x32_bf16 v[96:99], a[8:11], a[56:59], v[96:99]
    ds_read_b128 a[216:219], v37 offset:20480
    buffer_load_dwordx4 v32, s[20:23], s58 offen  lds
    v_mfma_f32_16x16x32_bf16 v[120:123], a[12:15], a[56:59], v[120:123]
    ds_read_b128 a[220:223], v37 offset:22528
    s_add_u32 m0, s75, 86016
    v_mfma_f32_16x16x32_bf16 v[100:103], a[8:11], a[60:63], v[100:103]
    s_add_u32 s58, s59, 786432
    v_mfma_f32_16x16x32_bf16 v[124:127], a[12:15], a[60:63], v[124:127]
    v_mfma_f32_16x16x32_bf16 v[128:131], a[8:11], a[88:91], v[128:131]
    buffer_load_dwordx4 v32, s[20:23], s58 offen  lds
    v_mfma_f32_16x16x32_bf16 v[152:155], a[12:15], a[88:91], v[152:155]
    s_add_u32 m0, s75, 87040
    s_add_u32 s58, s59, 794624
    v_mfma_f32_16x16x32_bf16 v[132:135], a[8:11], a[92:95], v[132:135]
    v_mfma_f32_16x16x32_bf16 v[156:159], a[12:15], a[92:95], v[156:159]
    v_mfma_f32_16x16x32_bf16 v[136:139], a[8:11], a[96:99], v[136:139]
    buffer_load_dwordx4 v33, s[20:23], s58 offen  lds
    v_mfma_f32_16x16x32_bf16 v[160:163], a[12:15], a[96:99], v[160:163]
    s_add_u32 m0, s75, 88064
    s_add_u32 s58, s59, 802816
    v_mfma_f32_16x16x32_bf16 v[140:143], a[8:11], a[100:103], v[140:143]
    v_mfma_f32_16x16x32_bf16 v[164:167], a[12:15], a[100:103], v[164:167]
    v_mfma_f32_16x16x32_bf16 v[144:147], a[8:11], a[104:107], v[144:147]
    buffer_load_dwordx4 v32, s[20:23], s58 offen  lds
    v_mfma_f32_16x16x32_bf16 v[168:171], a[12:15], a[104:107], v[168:171]
    v_mfma_f32_16x16x32_bf16 v[148:151], a[8:11], a[108:111], v[148:151]
    v_mfma_f32_16x16x32_bf16 v[172:175], a[12:15], a[108:111], v[172:175]
    s_waitcnt vmcnt(14)
    s_waitcnt lgkmcnt(0)
    s_barrier
    v_mfma_f32_16x16x32_bf16 v[80:83], a[112:115], a[128:131], v[80:83]
    v_add_u32 v36, 32768, v34
    v_xor_b32 v37, 0x40, v36
    v_mfma_f32_16x16x32_bf16 v[104:107], a[116:119], a[128:131], v[104:107]
    v_add_u32 v38, 57344, v24
    v_add_u32 v39, 57344, v25
    v_mfma_f32_16x16x32_bf16 v[84:87], a[112:115], a[132:135], v[84:87]
    ds_read_b64_tr_b16 a[0:1], v38 offset:0
    v_mfma_f32_16x16x32_bf16 v[108:111], a[116:119], a[132:135], v[108:111]
    ds_read_b64_tr_b16 a[2:3], v38 offset:4096
    v_mfma_f32_16x16x32_bf16 v[88:91], a[112:115], a[136:139], v[88:91]
    ds_read_b64_tr_b16 a[4:5], v39 offset:0
    v_mfma_f32_16x16x32_bf16 v[112:115], a[116:119], a[136:139], v[112:115]
    ds_read_b64_tr_b16 a[6:7], v39 offset:4096
    v_mfma_f32_16x16x32_bf16 v[92:95], a[112:115], a[140:143], v[92:95]
    ds_read_b128 a[16:19], v36 offset:0
    v_mfma_f32_16x16x32_bf16 v[116:119], a[116:119], a[140:143], v[116:119]
    ds_read_b128 a[20:23], v36 offset:2048
    v_mfma_f32_16x16x32_bf16 v[96:99], a[112:115], a[144:147], v[96:99]
    ds_read_b128 a[24:27], v36 offset:4096
    v_mfma_f32_16x16x32_bf16 v[120:123], a[116:119], a[144:147], v[120:123]
    ds_read_b128 a[28:31], v36 offset:6144
    v_mfma_f32_16x16x32_bf16 v[100:103], a[112:115], a[148:151], v[100:103]
    ds_read_b128 a[32:35], v36 offset:8192
    v_mfma_f32_16x16x32_bf16 v[124:127], a[116:119], a[148:151], v[124:127]
    ds_read_b128 a[36:39], v36 offset:10240
    v_mfma_f32_16x16x32_bf16 v[128:131], a[112:115], a[176:179], v[128:131]
    ds_read_b128 a[64:67], v36 offset:12288
    v_mfma_f32_16x16x32_bf16 v[152:155], a[116:119], a[176:179], v[152:155]
    ds_read_b128 a[68:71], v36 offset:14336
    v_mfma_f32_16x16x32_bf16 v[132:135], a[112:115], a[180:183], v[132:135]
    ds_read_b128 a[72:75], v36 offset:16384
    v_mfma_f32_16x16x32_bf16 v[156:159], a[116:119], a[180:183], v[156:159]
    ds_read_b128 a[76:79], v36 offset:18432
    v_mfma_f32_16x16x32_bf16 v[136:139], a[112:115], a[184:187], v[136:139]
    ds_read_b128 a[80:83], v36 offset:20480
    v_mfma_f32_16x16x32_bf16 v[160:163], a[116:119], a[184:187], v[160:163]
    ds_read_b128 a[84:87], v36 offset:22528
    v_mfma_f32_16x16x32_bf16 v[140:143], a[112:115], a[188:191], v[140:143]
    ds_read_b64_tr_b16 a[8:9], v38 offset:8192
    v_mfma_f32_16x16x32_bf16 v[164:167], a[116:119], a[188:191], v[164:167]
    ds_read_b64_tr_b16 a[10:11], v38 offset:12288
    v_mfma_f32_16x16x32_bf16 v[144:147], a[112:115], a[192:195], v[144:147]
    ds_read_b64_tr_b16 a[12:13], v39 offset:8192
    v_mfma_f32_16x16x32_bf16 v[168:171], a[116:119], a[192:195], v[168:171]
    ds_read_b64_tr_b16 a[14:15], v39 offset:12288
    v_mfma_f32_16x16x32_bf16 v[148:151], a[112:115], a[196:199], v[148:151]
    ds_read_b128 a[40:43], v37 offset:0
    v_mfma_f32_16x16x32_bf16 v[172:175], a[116:119], a[196:199], v[172:175]
    ds_read_b128 a[44:47], v37 offset:2048
    v_mfma_f32_16x16x32_bf16 v[80:83], a[120:123], a[152:155], v[80:83]
    ds_read_b128 a[48:51], v37 offset:4096
    v_mfma_f32_16x16x32_bf16 v[104:107], a[124:127], a[152:155], v[104:107]
    ds_read_b128 a[52:55], v37 offset:6144
    v_mfma_f32_16x16x32_bf16 v[84:87], a[120:123], a[156:159], v[84:87]
    ds_read_b128 a[56:59], v37 offset:8192
    v_mfma_f32_16x16x32_bf16 v[108:111], a[124:127], a[156:159], v[108:111]
    ds_read_b128 a[60:63], v37 offset:10240
    v_mfma_f32_16x16x32_bf16 v[88:91], a[120:123], a[160:163], v[88:91]
    ds_read_b128 a[88:91], v37 offset:12288
    v_mfma_f32_16x16x32_bf16 v[112:115], a[124:127], a[160:163], v[112:115]
    ds_read_b128 a[92:95], v37 offset:14336
    v_mfma_f32_16x16x32_bf16 v[92:95], a[120:123], a[164:167], v[92:95]
    ds_read_b128 a[96:99], v37 offset:16384
    v_mfma_f32_16x16x32_bf16 v[116:119], a[124:127], a[164:167], v[116:119]
    ds_read_b128 a[100:103], v37 offset:18432
    v_mfma_f32_16x16x32_bf16 v[96:99], a[120:123], a[168:171], v[96:99]
    ds_read_b128 a[104:107], v37 offset:20480
    v_mfma_f32_16x16x32_bf16 v[120:123], a[124:127], a[168:171], v[120:123]
    ds_read_b128 a[108:111], v37 offset:22528
    v_mfma_f32_16x16x32_bf16 v[100:103], a[120:123], a[172:175], v[100:103]
    v_mfma_f32_16x16x32_bf16 v[124:127], a[124:127], a[172:175], v[124:127]
    v_mfma_f32_16x16x32_bf16 v[128:131], a[120:123], a[200:203], v[128:131]
    v_mfma_f32_16x16x32_bf16 v[152:155], a[124:127], a[200:203], v[152:155]
    v_mfma_f32_16x16x32_bf16 v[132:135], a[120:123], a[204:207], v[132:135]
    v_mfma_f32_16x16x32_bf16 v[156:159], a[124:127], a[204:207], v[156:159]
    v_mfma_f32_16x16x32_bf16 v[136:139], a[120:123], a[208:211], v[136:139]
    v_mfma_f32_16x16x32_bf16 v[160:163], a[124:127], a[208:211], v[160:163]
    v_mfma_f32_16x16x32_bf16 v[140:143], a[120:123], a[212:215], v[140:143]
    v_mfma_f32_16x16x32_bf16 v[164:167], a[124:127], a[212:215], v[164:167]
    v_mfma_f32_16x16x32_bf16 v[144:147], a[120:123], a[216:219], v[144:147]
    v_mfma_f32_16x16x32_bf16 v[168:171], a[124:127], a[216:219], v[168:171]
    v_mfma_f32_16x16x32_bf16 v[148:151], a[120:123], a[220:223], v[148:151]
    v_mfma_f32_16x16x32_bf16 v[172:175], a[124:127], a[220:223], v[172:175]
    s_waitcnt vmcnt(0)
    s_waitcnt lgkmcnt(0)
    s_barrier
    v_mfma_f32_16x16x32_bf16 v[80:83], a[0:3], a[16:19], v[80:83]
    v_add_u32 v36, 73728, v34
    v_xor_b32 v37, 0x40, v36
    v_mfma_f32_16x16x32_bf16 v[104:107], a[4:7], a[16:19], v[104:107]
    v_add_u32 v38, 98304, v24
    v_add_u32 v39, 98304, v25
    v_mfma_f32_16x16x32_bf16 v[84:87], a[0:3], a[20:23], v[84:87]
    ds_read_b64_tr_b16 a[112:113], v38 offset:0
    s_mov_b32 m0, s55
    v_mfma_f32_16x16x32_bf16 v[108:111], a[4:7], a[20:23], v[108:111]
    ds_read_b64_tr_b16 a[114:115], v38 offset:4096
    buffer_load_dwordx4 v2, s[24:27], s54 offen offset:0 nt lds
    v_mfma_f32_16x16x32_bf16 v[88:91], a[0:3], a[24:27], v[88:91]
    ds_read_b64_tr_b16 a[116:117], v39 offset:0
    v_mfma_f32_16x16x32_bf16 v[112:115], a[4:7], a[24:27], v[112:115]
    ds_read_b64_tr_b16 a[118:119], v39 offset:4096
    v_mfma_f32_16x16x32_bf16 v[92:95], a[0:3], a[28:31], v[92:95]
    ds_read_b128 a[128:131], v36 offset:0
    v_mfma_f32_16x16x32_bf16 v[116:119], a[4:7], a[28:31], v[116:119]
    ds_read_b128 a[132:135], v36 offset:2048
    buffer_load_dwordx4 v3, s[24:27], s54 offen offset:1024 nt lds
    v_mfma_f32_16x16x32_bf16 v[96:99], a[0:3], a[32:35], v[96:99]
    ds_read_b128 a[136:139], v36 offset:4096
    v_mfma_f32_16x16x32_bf16 v[120:123], a[4:7], a[32:35], v[120:123]
    ds_read_b128 a[140:143], v36 offset:6144
    v_mfma_f32_16x16x32_bf16 v[100:103], a[0:3], a[36:39], v[100:103]
    ds_read_b128 a[144:147], v36 offset:8192
    v_mfma_f32_16x16x32_bf16 v[124:127], a[4:7], a[36:39], v[124:127]
    ds_read_b128 a[148:151], v36 offset:10240
    buffer_load_dwordx4 v4, s[24:27], s54 offen offset:2048 nt lds
    v_mfma_f32_16x16x32_bf16 v[128:131], a[0:3], a[64:67], v[128:131]
    ds_read_b128 a[176:179], v36 offset:12288
    v_mfma_f32_16x16x32_bf16 v[152:155], a[4:7], a[64:67], v[152:155]
    ds_read_b128 a[180:183], v36 offset:14336
    v_mfma_f32_16x16x32_bf16 v[132:135], a[0:3], a[68:71], v[132:135]
    ds_read_b128 a[184:187], v36 offset:16384
    v_mfma_f32_16x16x32_bf16 v[156:159], a[4:7], a[68:71], v[156:159]
    ds_read_b128 a[188:191], v36 offset:18432
    buffer_load_dwordx4 v5, s[24:27], s54 offen offset:3072 nt lds
    v_mfma_f32_16x16x32_bf16 v[136:139], a[0:3], a[72:75], v[136:139]
    ds_read_b128 a[192:195], v36 offset:20480
    s_add_u32 s54, s54, 16384
    v_mfma_f32_16x16x32_bf16 v[160:163], a[4:7], a[72:75], v[160:163]
    ds_read_b128 a[196:199], v36 offset:22528
    s_add_u32 s55, s55, 32768
    v_mfma_f32_16x16x32_bf16 v[140:143], a[0:3], a[76:79], v[140:143]
    ds_read_b64_tr_b16 a[120:121], v38 offset:8192
    s_cmp_ge_u32 s55, 98304
    v_mfma_f32_16x16x32_bf16 v[164:167], a[4:7], a[76:79], v[164:167]
    ds_read_b64_tr_b16 a[122:123], v38 offset:12288
    s_cselect_b32 s60, 98304, 0
    v_mfma_f32_16x16x32_bf16 v[144:147], a[0:3], a[80:83], v[144:147]
    ds_read_b64_tr_b16 a[124:125], v39 offset:8192
    s_sub_u32 s55, s55, s60
    v_mfma_f32_16x16x32_bf16 v[168:171], a[4:7], a[80:83], v[168:171]
    ds_read_b64_tr_b16 a[126:127], v39 offset:12288
    v_mfma_f32_16x16x32_bf16 v[148:151], a[0:3], a[84:87], v[148:151]
    ds_read_b128 a[152:155], v37 offset:0
    v_mfma_f32_16x16x32_bf16 v[172:175], a[4:7], a[84:87], v[172:175]
    ds_read_b128 a[156:159], v37 offset:2048
    v_mfma_f32_16x16x32_bf16 v[80:83], a[8:11], a[40:43], v[80:83]
    ds_read_b128 a[160:163], v37 offset:4096
    v_mfma_f32_16x16x32_bf16 v[104:107], a[12:15], a[40:43], v[104:107]
    ds_read_b128 a[164:167], v37 offset:6144
    v_mfma_f32_16x16x32_bf16 v[84:87], a[8:11], a[44:47], v[84:87]
    ds_read_b128 a[168:171], v37 offset:8192
    v_mfma_f32_16x16x32_bf16 v[108:111], a[12:15], a[44:47], v[108:111]
    ds_read_b128 a[172:175], v37 offset:10240
    v_mfma_f32_16x16x32_bf16 v[88:91], a[8:11], a[48:51], v[88:91]
    ds_read_b128 a[200:203], v37 offset:12288
    v_mfma_f32_16x16x32_bf16 v[112:115], a[12:15], a[48:51], v[112:115]
    ds_read_b128 a[204:207], v37 offset:14336
    v_mfma_f32_16x16x32_bf16 v[92:95], a[8:11], a[52:55], v[92:95]
    ds_read_b128 a[208:211], v37 offset:16384
    v_mfma_f32_16x16x32_bf16 v[116:119], a[12:15], a[52:55], v[116:119]
    ds_read_b128 a[212:215], v37 offset:18432
    v_mfma_f32_16x16x32_bf16 v[96:99], a[8:11], a[56:59], v[96:99]
    ds_read_b128 a[216:219], v37 offset:20480
    v_mfma_f32_16x16x32_bf16 v[120:123], a[12:15], a[56:59], v[120:123]
    ds_read_b128 a[220:223], v37 offset:22528
    v_mfma_f32_16x16x32_bf16 v[100:103], a[8:11], a[60:63], v[100:103]
    v_mfma_f32_16x16x32_bf16 v[124:127], a[12:15], a[60:63], v[124:127]
    v_mfma_f32_16x16x32_bf16 v[128:131], a[8:11], a[88:91], v[128:131]
    v_mfma_f32_16x16x32_bf16 v[152:155], a[12:15], a[88:91], v[152:155]
    v_mfma_f32_16x16x32_bf16 v[132:135], a[8:11], a[92:95], v[132:135]
    v_mfma_f32_16x16x32_bf16 v[156:159], a[12:15], a[92:95], v[156:159]
    v_mfma_f32_16x16x32_bf16 v[136:139], a[8:11], a[96:99], v[136:139]
    v_mfma_f32_16x16x32_bf16 v[160:163], a[12:15], a[96:99], v[160:163]
    v_mfma_f32_16x16x32_bf16 v[140:143], a[8:11], a[100:103], v[140:143]
    v_mfma_f32_16x16x32_bf16 v[164:167], a[12:15], a[100:103], v[164:167]
    v_mfma_f32_16x16x32_bf16 v[144:147], a[8:11], a[104:107], v[144:147]
    v_mfma_f32_16x16x32_bf16 v[168:171], a[12:15], a[104:107], v[168:171]
    v_mfma_f32_16x16x32_bf16 v[148:151], a[8:11], a[108:111], v[148:151]
    v_mfma_f32_16x16x32_bf16 v[172:175], a[12:15], a[108:111], v[172:175]
    s_waitcnt lgkmcnt(0)
    s_barrier
    v_mfma_f32_16x16x32_bf16 v[80:83], a[112:115], a[128:131], v[80:83]
    s_mov_b32 m0, s93
    s_nop 0
    buffer_load_dwordx4 v6, s[28:31], s92 offen offset:0 nt lds
    v_mfma_f32_16x16x32_bf16 v[104:107], a[116:119], a[128:131], v[104:107]
    v_mfma_f32_16x16x32_bf16 v[84:87], a[112:115], a[132:135], v[84:87]
    v_mfma_f32_16x16x32_bf16 v[108:111], a[116:119], a[132:135], v[108:111]
    v_mfma_f32_16x16x32_bf16 v[88:91], a[112:115], a[136:139], v[88:91]
    buffer_load_dwordx4 v7, s[28:31], s92 offen offset:1024 nt lds
    v_mfma_f32_16x16x32_bf16 v[112:115], a[116:119], a[136:139], v[112:115]
    v_mfma_f32_16x16x32_bf16 v[92:95], a[112:115], a[140:143], v[92:95]
    v_mfma_f32_16x16x32_bf16 v[116:119], a[116:119], a[140:143], v[116:119]
    v_mfma_f32_16x16x32_bf16 v[96:99], a[112:115], a[144:147], v[96:99]
    buffer_load_dwordx4 v6, s[28:31], s92 offen offset:2048 nt lds
    v_mfma_f32_16x16x32_bf16 v[120:123], a[116:119], a[144:147], v[120:123]
    v_mfma_f32_16x16x32_bf16 v[100:103], a[112:115], a[148:151], v[100:103]
    v_mfma_f32_16x16x32_bf16 v[124:127], a[116:119], a[148:151], v[124:127]
    v_mfma_f32_16x16x32_bf16 v[128:131], a[112:115], a[176:179], v[128:131]
    buffer_load_dwordx4 v7, s[28:31], s92 offen offset:3072 nt lds
    v_mfma_f32_16x16x32_bf16 v[152:155], a[116:119], a[176:179], v[152:155]
    s_add_u32 s92, s92, 16384
    s_add_u32 s93, s93, 32768
    v_mfma_f32_16x16x32_bf16 v[132:135], a[112:115], a[180:183], v[132:135]
    s_cmp_ge_u32 s93, 98304
    s_cselect_b32 s60, 98304, 0
    v_mfma_f32_16x16x32_bf16 v[156:159], a[116:119], a[180:183], v[156:159]
    s_sub_u32 s93, s93, s60
    s_mov_b32 m0, s55
    v_mfma_f32_16x16x32_bf16 v[136:139], a[112:115], a[184:187], v[136:139]
    buffer_load_dwordx4 v2, s[24:27], s54 offen offset:0 nt lds
    v_mfma_f32_16x16x32_bf16 v[160:163], a[116:119], a[184:187], v[160:163]
    v_mfma_f32_16x16x32_bf16 v[140:143], a[112:115], a[188:191], v[140:143]
    v_mfma_f32_16x16x32_bf16 v[164:167], a[116:119], a[188:191], v[164:167]
    v_mfma_f32_16x16x32_bf16 v[144:147], a[112:115], a[192:195], v[144:147]
    buffer_load_dwordx4 v3, s[24:27], s54 offen offset:1024 nt lds
    v_mfma_f32_16x16x32_bf16 v[168:171], a[116:119], a[192:195], v[168:171]
    v_mfma_f32_16x16x32_bf16 v[148:151], a[112:115], a[196:199], v[148:151]
    v_mfma_f32_16x16x32_bf16 v[172:175], a[116:119], a[196:199], v[172:175]
    v_mfma_f32_16x16x32_bf16 v[80:83], a[120:123], a[152:155], v[80:83]
    buffer_load_dwordx4 v4, s[24:27], s54 offen offset:2048 nt lds
    v_mfma_f32_16x16x32_bf16 v[104:107], a[124:127], a[152:155], v[104:107]
    v_mfma_f32_16x16x32_bf16 v[84:87], a[120:123], a[156:159], v[84:87]
    v_mfma_f32_16x16x32_bf16 v[108:111], a[124:127], a[156:159], v[108:111]
    v_mfma_f32_16x16x32_bf16 v[88:91], a[120:123], a[160:163], v[88:91]
    buffer_load_dwordx4 v5, s[24:27], s54 offen offset:3072 nt lds
    v_mfma_f32_16x16x32_bf16 v[112:115], a[124:127], a[160:163], v[112:115]
    s_add_u32 s54, s54, 16384
    s_add_u32 s55, s55, 32768
    v_mfma_f32_16x16x32_bf16 v[92:95], a[120:123], a[164:167], v[92:95]
    s_cmp_ge_u32 s55, 98304
    s_cselect_b32 s60, 98304, 0
    v_mfma_f32_16x16x32_bf16 v[116:119], a[124:127], a[164:167], v[116:119]
    s_sub_u32 s55, s55, s60
    v_mfma_f32_16x16x32_bf16 v[96:99], a[120:123], a[168:171], v[96:99]
    v_mfma_f32_16x16x32_bf16 v[120:123], a[124:127], a[168:171], v[120:123]
    v_mfma_f32_16x16x32_bf16 v[100:103], a[120:123], a[172:175], v[100:103]
    v_mfma_f32_16x16x32_bf16 v[124:127], a[124:127], a[172:175], v[124:127]
    v_mfma_f32_16x16x32_bf16 v[128:131], a[120:123], a[200:203], v[128:131]
    v_mfma_f32_16x16x32_bf16 v[152:155], a[124:127], a[200:203], v[152:155]
    v_mfma_f32_16x16x32_bf16 v[132:135], a[120:123], a[204:207], v[132:135]
    v_mfma_f32_16x16x32_bf16 v[156:159], a[124:127], a[204:207], v[156:159]
    v_mfma_f32_16x16x32_bf16 v[136:139], a[120:123], a[208:211], v[136:139]
    v_mfma_f32_16x16x32_bf16 v[160:163], a[124:127], a[208:211], v[160:163]
    v_mfma_f32_16x16x32_bf16 v[140:143], a[120:123], a[212:215], v[140:143]
    v_mfma_f32_16x16x32_bf16 v[164:167], a[124:127], a[212:215], v[164:167]
    v_mfma_f32_16x16x32_bf16 v[144:147], a[120:123], a[216:219], v[144:147]
    v_mfma_f32_16x16x32_bf16 v[168:171], a[124:127], a[216:219], v[168:171]
    v_mfma_f32_16x16x32_bf16 v[148:151], a[120:123], a[220:223], v[148:151]
    v_mfma_f32_16x16x32_bf16 v[172:175], a[124:127], a[220:223], v[172:175]
    s_cmp_lg_u32 s48, 0
    s_cbranch_scc1 L_w0_2
    v_mov_b32 v204, 1
    v_mov_b32 v205, 0
    s_mov_b64 exec, 1
    buffer_atomic_add v204, v205, s[96:99], 0 offen sc1
    s_mov_b64 exec, -1
L_w0_2:
    v_lshrrev_b32 v26, 4, v0
    v_and_b32 v27, 15, v0
    v_lshrrev_b32 v28, 1, v26
    s_lshl_b32 s57, s48, 2
    v_add_u32 v28, s57, v28
    v_xor_b32 v28, v28, v27
    v_lshlrev_b32 v28, 4, v28
    v_lshl_add_u32 v28, v27, 8, v28
    v_and_b32 v26, 1, v26
    v_lshl_add_u32 v28, v26, 3, v28
    v_add_u32 v28, 114688, v28
    v_xor_b32 v29, 0x20, v28
    s_mov_b32 s58, 0x3e0293ee
    v_mul_f32 v80, s58, v80
    v_mul_f32 v81, s58, v81
    v_mul_f32 v82, s58, v82
    v_mul_f32 v83, s58, v83
    v_cvt_pk_bf16_f32 v80, v80, v81
    v_cvt_pk_bf16_f32 v81, v82, v83
    ds_write_b64 v28, v[80:81] offset:0
    v_mul_f32 v104, s58, v104
    v_mul_f32 v105, s58, v105
    v_mul_f32 v106, s58, v106
    v_mul_f32 v107, s58, v107
    v_cvt_pk_bf16_f32 v104, v104, v105
    v_cvt_pk_bf16_f32 v105, v106, v107
    ds_write_b64 v29, v[104:105] offset:0
    v_mul_f32 v84, s58, v84
    v_mul_f32 v85, s58, v85
    v_mul_f32 v86, s58, v86
    v_mul_f32 v87, s58, v87
    v_cvt_pk_bf16_f32 v84, v84, v85
    v_cvt_pk_bf16_f32 v85, v86, v87
    ds_write_b64 v28, v[84:85] offset:4096
    v_mul_f32 v108, s58, v108
    v_mul_f32 v109, s58, v109
    v_mul_f32 v110, s58, v110
    v_mul_f32 v111, s58, v111
    v_cvt_pk_bf16_f32 v108, v108, v109
    v_cvt_pk_bf16_f32 v109, v110, v111
    ds_write_b64 v29, v[108:109] offset:4096
    v_mul_f32 v88, s58, v88
    v_mul_f32 v89, s58, v89
    v_mul_f32 v90, s58, v90
    v_mul_f32 v91, s58, v91
    v_cvt_pk_bf16_f32 v88, v88, v89
    v_cvt_pk_bf16_f32 v89, v90, v91
    ds_write_b64 v28, v[88:89] offset:8192
    v_mul_f32 v112, s58, v112
    v_mul_f32 v113, s58, v113
    v_mul_f32 v114, s58, v114
    v_mul_f32 v115, s58, v115
    v_cvt_pk_bf16_f32 v112, v112, v113
    v_cvt_pk_bf16_f32 v113, v114, v115
    ds_write_b64 v29, v[112:113] offset:8192
    v_mul_f32 v92, s58, v92
    v_mul_f32 v93, s58, v93
    v_mul_f32 v94, s58, v94
    v_mul_f32 v95, s58, v95
    v_cvt_pk_bf16_f32 v92, v92, v93
    v_cvt_pk_bf16_f32 v93, v94, v95
    ds_write_b64 v28, v[92:93] offset:12288
    v_mul_f32 v116, s58, v116
    v_mul_f32 v117, s58, v117
    v_mul_f32 v118, s58, v118
    v_mul_f32 v119, s58, v119
    v_cvt_pk_bf16_f32 v116, v116, v117
    v_cvt_pk_bf16_f32 v117, v118, v119
    ds_write_b64 v29, v[116:117] offset:12288
    v_mul_f32 v96, s58, v96
    v_mul_f32 v97, s58, v97
    v_mul_f32 v98, s58, v98
    v_mul_f32 v99, s58, v99
    v_cvt_pk_bf16_f32 v96, v96, v97
    v_cvt_pk_bf16_f32 v97, v98, v99
    ds_write_b64 v28, v[96:97] offset:16384
    v_mul_f32 v120, s58, v120
    v_mul_f32 v121, s58, v121
    v_mul_f32 v122, s58, v122
    v_mul_f32 v123, s58, v123
    v_cvt_pk_bf16_f32 v120, v120, v121
    v_cvt_pk_bf16_f32 v121, v122, v123
    ds_write_b64 v29, v[120:121] offset:16384
    v_mul_f32 v100, s58, v100
    v_mul_f32 v101, s58, v101
    v_mul_f32 v102, s58, v102
    v_mul_f32 v103, s58, v103
    v_cvt_pk_bf16_f32 v100, v100, v101
    v_cvt_pk_bf16_f32 v101, v102, v103
    ds_write_b64 v28, v[100:101] offset:20480
    v_mul_f32 v124, s58, v124
    v_mul_f32 v125, s58, v125
    v_mul_f32 v126, s58, v126
    v_mul_f32 v127, s58, v127
    v_cvt_pk_bf16_f32 v124, v124, v125
    v_cvt_pk_bf16_f32 v125, v126, v127
    ds_write_b64 v29, v[124:125] offset:20480
    s_waitcnt lgkmcnt(0)
    s_barrier
    v_lshrrev_b32 v26, 4, v0
    v_and_b32 v27, 15, v0
    v_xor_b32 v28, v26, v27
    v_lshlrev_b32 v28, 4, v28
    v_lshl_add_u32 v28, v27, 8, v28
    s_mul_i32 s57, s49, 12288
    s_add_u32 s57, s57, 114688
    v_add_u32 v192, s57, v28
    v_xor_b32 v193, 64, v192
    v_xor_b32 v194, 128, v192
    v_xor_b32 v195, 192, v192
    ds_read_b128 a[0:3], v192 offset:0
    ds_read_b128 a[4:7], v192 offset:4096
    ds_read_b128 a[8:11], v192 offset:8192
    ds_read_b128 a[12:15], v193 offset:0
    ds_read_b128 a[16:19], v193 offset:4096
    ds_read_b128 a[20:23], v193 offset:8192
    ds_read_b128 a[24:27], v194 offset:0
    ds_read_b128 a[28:31], v194 offset:4096
    ds_read_b128 a[32:35], v194 offset:8192
    ds_read_b128 a[36:39], v195 offset:0
    ds_read_b128 a[40:43], v195 offset:4096
    ds_read_b128 a[44:47], v195 offset:8192
    s_waitcnt lgkmcnt(0)
    s_barrier
    v_lshrrev_b32 v26, 4, v0
    v_and_b32 v27, 15, v0
    v_lshrrev_b32 v28, 1, v26
    s_lshl_b32 s57, s48, 2
    v_add_u32 v28, s57, v28
    v_xor_b32 v28, v28, v27
    v_lshlrev_b32 v28, 4, v28
    v_lshl_add_u32 v28, v27, 8, v28
    v_and_b32 v26, 1, v26
    v_lshl_add_u32 v28, v26, 3, v28
    v_add_u32 v28, 139264, v28
    v_xor_b32 v29, 0x20, v28
    s_mov_b32 s58, 0x3e0293ee
    v_mul_f32 v128, s58, v128
    v_mul_f32 v129, s58, v129
    v_mul_f32 v130, s58, v130
    v_mul_f32 v131, s58, v131
    v_cvt_pk_bf16_f32 v128, v128, v129
    v_cvt_pk_bf16_f32 v129, v130, v131
    ds_write_b64 v28, v[128:129] offset:0
    v_mul_f32 v152, s58, v152
    v_mul_f32 v153, s58, v153
    v_mul_f32 v154, s58, v154
    v_mul_f32 v155, s58, v155
    v_cvt_pk_bf16_f32 v152, v152, v153
    v_cvt_pk_bf16_f32 v153, v154, v155
    ds_write_b64 v29, v[152:153] offset:0
    v_mul_f32 v132, s58, v132
    v_mul_f32 v133, s58, v133
    v_mul_f32 v134, s58, v134
    v_mul_f32 v135, s58, v135
    v_cvt_pk_bf16_f32 v132, v132, v133
    v_cvt_pk_bf16_f32 v133, v134, v135
    ds_write_b64 v28, v[132:133] offset:4096
    v_mul_f32 v156, s58, v156
    v_mul_f32 v157, s58, v157
    v_mul_f32 v158, s58, v158
    v_mul_f32 v159, s58, v159
    v_cvt_pk_bf16_f32 v156, v156, v157
    v_cvt_pk_bf16_f32 v157, v158, v159
    ds_write_b64 v29, v[156:157] offset:4096
    v_mul_f32 v136, s58, v136
    v_mul_f32 v137, s58, v137
    v_mul_f32 v138, s58, v138
    v_mul_f32 v139, s58, v139
    v_cvt_pk_bf16_f32 v136, v136, v137
    v_cvt_pk_bf16_f32 v137, v138, v139
    ds_write_b64 v28, v[136:137] offset:8192
    v_mul_f32 v160, s58, v160
    v_mul_f32 v161, s58, v161
    v_mul_f32 v162, s58, v162
    v_mul_f32 v163, s58, v163
    v_cvt_pk_bf16_f32 v160, v160, v161
    v_cvt_pk_bf16_f32 v161, v162, v163
    ds_write_b64 v29, v[160:161] offset:8192
    v_mul_f32 v140, s58, v140
    v_mul_f32 v141, s58, v141
    v_mul_f32 v142, s58, v142
    v_mul_f32 v143, s58, v143
    v_cvt_pk_bf16_f32 v140, v140, v141
    v_cvt_pk_bf16_f32 v141, v142, v143
    ds_write_b64 v28, v[140:141] offset:12288
    v_mul_f32 v164, s58, v164
    v_mul_f32 v165, s58, v165
    v_mul_f32 v166, s58, v166
    v_mul_f32 v167, s58, v167
    v_cvt_pk_bf16_f32 v164, v164, v165
    v_cvt_pk_bf16_f32 v165, v166, v167
    ds_write_b64 v29, v[164:165] offset:12288
    v_mul_f32 v144, s58, v144
    v_mul_f32 v145, s58, v145
    v_mul_f32 v146, s58, v146
    v_mul_f32 v147, s58, v147
    v_cvt_pk_bf16_f32 v144, v144, v145
    v_cvt_pk_bf16_f32 v145, v146, v147
    ds_write_b64 v28, v[144:145] offset:16384
    v_mul_f32 v168, s58, v168
    v_mul_f32 v169, s58, v169
    v_mul_f32 v170, s58, v170
    v_mul_f32 v171, s58, v171
    v_cvt_pk_bf16_f32 v168, v168, v169
    v_cvt_pk_bf16_f32 v169, v170, v171
    ds_write_b64 v29, v[168:169] offset:16384
    v_mul_f32 v148, s58, v148
    v_mul_f32 v149, s58, v149
    v_mul_f32 v150, s58, v150
    v_mul_f32 v151, s58, v151
    v_cvt_pk_bf16_f32 v148, v148, v149
    v_cvt_pk_bf16_f32 v149, v150, v151
    ds_write_b64 v28, v[148:149] offset:20480
    v_mul_f32 v172, s58, v172
    v_mul_f32 v173, s58, v173
    v_mul_f32 v174, s58, v174
    v_mul_f32 v175, s58, v175
    v_cvt_pk_bf16_f32 v172, v172, v173
    v_cvt_pk_bf16_f32 v173, v174, v175
    ds_write_b64 v29, v[172:173] offset:20480
    s_add_u32 s65, s65, 32768
    s_cmp_ge_u32 s65, 98304
    ds_read_b128 a[48:51], v8 offset:0
    s_cselect_b32 s59, 98304, 0
    s_sub_u32 s65, s65, s59
    s_sub_u32 s67, 32768, s59
    ds_read_b128 a[64:67], v8 offset:4096
    v_add_u32 v8, s67, v8
    ds_read_b128 a[52:55], v9 offset:0
    ds_read_b128 a[68:71], v9 offset:4096
    v_add_u32 v9, s67, v9
    ds_read_b128 a[56:59], v10 offset:0
    ds_read_b128 a[72:75], v10 offset:4096
    v_add_u32 v10, s67, v10
    ds_read_b128 a[60:63], v11 offset:0
    s_waitcnt lgkmcnt(6)
    v_mfma_f32_16x16x32_bf16 v[32:35], a[48:51], a[0:3], 0
    ds_read_b128 a[76:79], v11 offset:4096
    s_waitcnt lgkmcnt(6)
    v_mfma_f32_16x16x32_bf16 v[44:47], a[64:67], a[0:3], 0
    v_add_u32 v11, s67, v11
    ds_read_b64_tr_b16 a[80:81], v12
    s_waitcnt lgkmcnt(6)
    v_mfma_f32_16x16x32_bf16 v[32:35], a[52:55], a[12:15], v[32:35]
    ds_read_b64_tr_b16 a[82:83], v12 offset:4096
    v_add_u32 v12, s67, v12
    s_waitcnt lgkmcnt(6)
    v_mfma_f32_16x16x32_bf16 v[44:47], a[68:71], a[12:15], v[44:47]
    ds_read_b64_tr_b16 a[84:85], v13
    v_mfma_f32_16x16x32_bf16 v[36:39], a[48:51], a[4:7], 0
    ds_read_b64_tr_b16 a[86:87], v13 offset:4096
    v_add_u32 v13, s67, v13
    s_waitcnt lgkmcnt(7)
    v_mfma_f32_16x16x32_bf16 v[32:35], a[56:59], a[24:27], v[32:35]
    ds_read_b64_tr_b16 a[88:89], v14
    v_mfma_f32_16x16x32_bf16 v[48:51], a[64:67], a[4:7], 0
    ds_read_b64_tr_b16 a[90:91], v14 offset:4096
    v_add_u32 v14, s67, v14
    s_waitcnt lgkmcnt(8)
    v_mfma_f32_16x16x32_bf16 v[44:47], a[72:75], a[24:27], v[44:47]
    ds_read_b64_tr_b16 a[92:93], v15
    v_mfma_f32_16x16x32_bf16 v[40:43], a[48:51], a[8:11], 0
    ds_read_b64_tr_b16 a[94:95], v15 offset:4096
    v_add_u32 v15, s67, v15
    s_waitcnt lgkmcnt(9)
    v_mfma_f32_16x16x32_bf16 v[32:35], a[60:63], a[36:39], v[32:35]
    ds_read_b64_tr_b16 a[96:97], v16
    v_mfma_f32_16x16x32_bf16 v[52:55], a[64:67], a[8:11], 0
    ds_read_b64_tr_b16 a[98:99], v16 offset:4096
    v_add_u32 v16, s67, v16
    s_waitcnt lgkmcnt(10)
    v_mfma_f32_16x16x32_bf16 v[44:47], a[76:79], a[36:39], v[44:47]
    ds_read_b64_tr_b16 a[100:101], v17
    s_nop 0
    v_max3_f32 v192, v32, v33, v34
    v_mfma_f32_16x16x32_bf16 v[36:39], a[52:55], a[16:19], v[36:39]
    ds_read_b64_tr_b16 a[102:103], v17 offset:4096
    v_add_u32 v17, s67, v17
    v_mfma_f32_16x16x32_bf16 v[48:51], a[68:71], a[16:19], v[48:51]
    ds_read_b64_tr_b16 a[104:105], v18
    v_max3_f32 v193, v35, v44, v45
    v_mfma_f32_16x16x32_bf16 v[36:39], a[56:59], a[28:31], v[36:39]
    ds_read_b64_tr_b16 a[106:107], v18 offset:4096
    v_max3_f32 v193, v193, v46, v47
    v_mfma_f32_16x16x32_bf16 v[48:51], a[72:75], a[28:31], v[48:51]
    ds_read_b64_tr_b16 a[108:109], v19
    v_max_f32 v192, v192, v193
    v_mfma_f32_16x16x32_bf16 v[36:39], a[60:63], a[40:43], v[36:39]
    ds_read_b64_tr_b16 a[110:111], v19 offset:4096
    v_mov_b32 v193, v192
    v_mfma_f32_16x16x32_bf16 v[48:51], a[76:79], a[40:43], v[48:51]
    s_nop 0
    v_permlane16_swap_b32 v192, v193
    v_max_f32 v192, v192, v193
    v_mfma_f32_16x16x32_bf16 v[40:43], a[52:55], a[20:23], v[40:43]
    v_mov_b32 v193, v192
    s_nop 1
    v_permlane32_swap_b32 v192, v193
    v_mfma_f32_16x16x32_bf16 v[52:55], a[68:71], a[20:23], v[52:55]
    v_max_f32 v192, v192, v193
    v_sub_f32 v56, 0, v192
    v_mfma_f32_16x16x32_bf16 v[40:43], a[56:59], a[32:35], v[40:43]
    v_sub_f32 v57, 0, v192
    v_sub_f32 v58, 0, v192
    v_mfma_f32_16x16x32_bf16 v[52:55], a[72:75], a[32:35], v[52:55]
    v_sub_f32 v59, 0, v192
    v_sub_f32 v32, v32, v192
    v_mfma_f32_16x16x32_bf16 v[40:43], a[60:63], a[44:47], v[40:43]
    v_sub_f32 v33, v33, v192
    v_sub_f32 v34, v34, v192
    v_mfma_f32_16x16x32_bf16 v[52:55], a[76:79], a[44:47], v[52:55]
    v_sub_f32 v35, v35, v192
    v_sub_f32 v44, v44, v192
    v_sub_f32 v45, v45, v192
    v_sub_f32 v46, v46, v192
    v_sub_f32 v47, v47, v192
    v_exp_f32 v32, v32
    v_exp_f32 v33, v33
    v_exp_f32 v34, v34
    v_exp_f32 v35, v35
    v_cvt_pk_bf16_f32 v68, v32, v33
    v_cvt_pk_bf16_f32 v69, v34, v35
    v_exp_f32 v44, v44
    v_exp_f32 v45, v45
    v_exp_f32 v46, v46
    v_exp_f32 v47, v47
    v_cvt_pk_bf16_f32 v70, v44, v45
    v_cvt_pk_bf16_f32 v71, v46, v47
    v_max3_f32 v194, v36, v37, v38
    v_max3_f32 v195, v39, v48, v49
    s_waitcnt lgkmcnt(14)
    v_mfma_f32_16x16x32_bf16 v[80:83], a[80:83], v[68:71], 0
    v_max3_f32 v195, v195, v50, v51
    v_max_f32 v194, v194, v195
    s_waitcnt lgkmcnt(12)
    v_mfma_f32_16x16x32_bf16 v[92:95], a[84:87], v[68:71], 0
    v_mov_b32 v195, v194
    s_nop 1
    v_permlane16_swap_b32 v194, v195
    s_waitcnt lgkmcnt(10)
    v_mfma_f32_16x16x32_bf16 v[104:107], a[88:91], v[68:71], 0
    v_max_f32 v194, v194, v195
    v_mov_b32 v195, v194
    s_waitcnt lgkmcnt(8)
    v_mfma_f32_16x16x32_bf16 v[116:119], a[92:95], v[68:71], 0
    v_permlane32_swap_b32 v194, v195
    v_max_f32 v194, v194, v195
    s_waitcnt lgkmcnt(6)
    v_mfma_f32_16x16x32_bf16 v[128:131], a[96:99], v[68:71], 0
    v_sub_f32 v60, 0, v194
    v_sub_f32 v61, 0, v194
    s_waitcnt lgkmcnt(4)
    v_mfma_f32_16x16x32_bf16 v[140:143], a[100:103], v[68:71], 0
    v_sub_f32 v62, 0, v194
    v_sub_f32 v63, 0, v194
    s_waitcnt lgkmcnt(2)
    v_mfma_f32_16x16x32_bf16 v[152:155], a[104:107], v[68:71], 0
    v_sub_f32 v36, v36, v194
    v_sub_f32 v37, v37, v194
    s_waitcnt lgkmcnt(0)
    v_mfma_f32_16x16x32_bf16 v[164:167], a[108:111], v[68:71], 0
    v_sub_f32 v38, v38, v194
    v_sub_f32 v39, v39, v194
    v_mfma_f32_16x16x32_bf16 v[176:179], v[188:191], v[68:71], 0
    v_sub_f32 v48, v48, v194
    v_sub_f32 v49, v49, v194
    v_sub_f32 v50, v50, v194
    v_sub_f32 v51, v51, v194
    v_exp_f32 v36, v36
    v_exp_f32 v37, v37
    v_exp_f32 v38, v38
    v_exp_f32 v39, v39
    v_cvt_pk_bf16_f32 v72, v36, v37
    v_cvt_pk_bf16_f32 v73, v38, v39
    v_exp_f32 v48, v48
    v_exp_f32 v49, v49
    v_exp_f32 v50, v50
    v_exp_f32 v51, v51
    v_cvt_pk_bf16_f32 v74, v48, v49
    v_cvt_pk_bf16_f32 v75, v50, v51
    v_max3_f32 v196, v40, v41, v42
    v_max3_f32 v197, v43, v52, v53
    v_mfma_f32_16x16x32_bf16 v[84:87], a[80:83], v[72:75], 0
    v_max3_f32 v197, v197, v54, v55
    v_max_f32 v196, v196, v197
    v_mfma_f32_16x16x32_bf16 v[96:99], a[84:87], v[72:75], 0
    v_mov_b32 v197, v196
    s_nop 1
    v_permlane16_swap_b32 v196, v197
    v_mfma_f32_16x16x32_bf16 v[108:111], a[88:91], v[72:75], 0
    v_max_f32 v196, v196, v197
    v_mov_b32 v197, v196
    v_mfma_f32_16x16x32_bf16 v[120:123], a[92:95], v[72:75], 0
    s_nop 0
    v_permlane32_swap_b32 v196, v197
    v_max_f32 v196, v196, v197
    v_mfma_f32_16x16x32_bf16 v[132:135], a[96:99], v[72:75], 0
    v_sub_f32 v64, 0, v196
    v_sub_f32 v65, 0, v196
    v_mfma_f32_16x16x32_bf16 v[144:147], a[100:103], v[72:75], 0
    v_sub_f32 v66, 0, v196
    v_sub_f32 v67, 0, v196
    v_mfma_f32_16x16x32_bf16 v[156:159], a[104:107], v[72:75], 0
    v_sub_f32 v40, v40, v196
    v_sub_f32 v41, v41, v196
    v_mfma_f32_16x16x32_bf16 v[168:171], a[108:111], v[72:75], 0
    v_sub_f32 v42, v42, v196
    v_sub_f32 v43, v43, v196
    v_mfma_f32_16x16x32_bf16 v[180:183], v[188:191], v[72:75], 0
    v_sub_f32 v52, v52, v196
    v_sub_f32 v53, v53, v196
    v_sub_f32 v54, v54, v196
    v_sub_f32 v55, v55, v196
    v_exp_f32 v40, v40
    v_exp_f32 v41, v41
    v_exp_f32 v42, v42
    v_exp_f32 v43, v43
    v_cvt_pk_bf16_f32 v76, v40, v41
    v_cvt_pk_bf16_f32 v77, v42, v43
    v_exp_f32 v52, v52
    v_exp_f32 v53, v53
    v_exp_f32 v54, v54
    v_exp_f32 v55, v55
    v_cvt_pk_bf16_f32 v78, v52, v53
    v_cvt_pk_bf16_f32 v79, v54, v55
    v_add_u32 v18, s67, v18
    v_add_u32 v19, s67, v19
    v_mfma_f32_16x16x32_bf16 v[88:91], a[80:83], v[76:79], 0
    v_mfma_f32_16x16x32_bf16 v[100:103], a[84:87], v[76:79], 0
    v_mfma_f32_16x16x32_bf16 v[112:115], a[88:91], v[76:79], 0
    v_mfma_f32_16x16x32_bf16 v[124:127], a[92:95], v[76:79], 0
    v_mfma_f32_16x16x32_bf16 v[136:139], a[96:99], v[76:79], 0
    v_mfma_f32_16x16x32_bf16 v[148:151], a[100:103], v[76:79], 0
    v_mfma_f32_16x16x32_bf16 v[160:163], a[104:107], v[76:79], 0
    v_mfma_f32_16x16x32_bf16 v[172:175], a[108:111], v[76:79], 0
    v_mfma_f32_16x16x32_bf16 v[184:187], v[188:191], v[76:79], 0
    s_mov_b32 s53, 15
L_loop_3:
    s_cmp_eq_u32 s53, 2
    s_cselect_b32 s54, s56, s54
    s_cmp_eq_u32 s53, 1
    s_cselect_b32 s92, s56, s92
    s_waitcnt vmcnt(4)
    s_mov_b32 s60, 0xe38
    s_bitcmp1_b32 s60, s53
    s_cbranch_scc1 L_fd_4
L_fb_5:
    s_barrier
    s_mov_b32 s60, 0x3cf0
    s_bitcmp1_b32 s60, s53
    s_cbranch_scc1 L_fd_6
L_fb_7:
    s_mov_b32 m0, s93
    s_nop 0
    buffer_load_dwordx4 v6, s[28:31], s92 offen offset:0 nt lds
    s_waitcnt lgkmcnt(15)
    ds_read_b128 a[48:51], v8 offset:0
    ds_read_b128 a[64:67], v8 offset:4096
    ds_read_b128 a[52:55], v9 offset:0
    ds_read_b128 a[68:71], v9 offset:4096
    buffer_load_dwordx4 v7, s[28:31], s92 offen offset:1024 nt lds
    ds_read_b128 a[56:59], v10 offset:0
    ds_read_b128 a[72:75], v10 offset:4096
    ds_read_b128 a[60:63], v11 offset:0
    s_waitcnt lgkmcnt(6)
    v_mfma_f32_16x16x32_bf16 v[32:35], a[48:51], a[0:3], v[56:59]
    ds_read_b128 a[76:79], v11 offset:4096
    s_waitcnt lgkmcnt(6)
    v_mfma_f32_16x16x32_bf16 v[44:47], a[64:67], a[0:3], v[56:59]
    buffer_load_dwordx4 v6, s[28:31], s92 offen offset:2048 nt lds
    s_waitcnt lgkmcnt(5)
    v_mfma_f32_16x16x32_bf16 v[32:35], a[52:55], a[12:15], v[32:35]
    ds_read_b64_tr_b16 a[80:81], v12
    s_waitcnt lgkmcnt(5)
    v_mfma_f32_16x16x32_bf16 v[44:47], a[68:71], a[12:15], v[44:47]
    ds_read_b64_tr_b16 a[82:83], v12 offset:4096
    s_waitcnt lgkmcnt(5)
    v_mfma_f32_16x16x32_bf16 v[32:35], a[56:59], a[24:27], v[32:35]
    ds_read_b64_tr_b16 a[84:85], v13
    s_waitcnt lgkmcnt(5)
    v_mfma_f32_16x16x32_bf16 v[44:47], a[72:75], a[24:27], v[44:47]
    buffer_load_dwordx4 v7, s[28:31], s92 offen offset:3072 nt lds
    s_waitcnt lgkmcnt(4)
    v_mfma_f32_16x16x32_bf16 v[32:35], a[60:63], a[36:39], v[32:35]
    s_add_u32 s92, s92, 16384
    s_add_u32 s93, s93, 32768
    s_waitcnt lgkmcnt(3)
    v_mfma_f32_16x16x32_bf16 v[44:47], a[76:79], a[36:39], v[44:47]
    s_cmp_ge_u32 s93, 98304
    s_cselect_b32 s60, 98304, 0
    v_mfma_f32_16x16x32_bf16 v[36:39], a[48:51], a[4:7], v[60:63]
    s_sub_u32 s93, s93, s60
    ds_read_b64_tr_b16 a[86:87], v13 offset:4096
    v_mfma_f32_16x16x32_bf16 v[48:51], a[64:67], a[4:7], v[60:63]
    ds_read_b64_tr_b16 a[88:89], v14
    v_max3_f32 v192, v32, v33, v34
    v_mfma_f32_16x16x32_bf16 v[36:39], a[52:55], a[16:19], v[36:39]
    ds_read_b64_tr_b16 a[90:91], v14 offset:4096
    v_max3_f32 v193, v35, v44, v45
    v_mfma_f32_16x16x32_bf16 v[48:51], a[68:71], a[16:19], v[48:51]
    ds_read_b64_tr_b16 a[92:93], v15
    v_max3_f32 v193, v193, v46, v47
    v_mfma_f32_16x16x32_bf16 v[36:39], a[56:59], a[28:31], v[36:39]
    ds_read_b64_tr_b16 a[94:95], v15 offset:4096
    v_max_f32 v192, v192, v193
    v_mfma_f32_16x16x32_bf16 v[48:51], a[72:75], a[28:31], v[48:51]
    v_cmp_lt_f32 vcc, 0x41000000, v192
    v_mfma_f32_16x16x32_bf16 v[36:39], a[60:63], a[40:43], v[36:39]
    v_mfma_f32_16x16x32_bf16 v[48:51], a[76:79], a[40:43], v[48:51]
    s_nop 1
    s_cbranch_vccnz L_rare_8
L_back_9:
    v_mfma_f32_16x16x32_bf16 v[40:43], a[48:51], a[8:11], v[64:67]
    ds_read_b64_tr_b16 a[96:97], v16
    v_exp_f32 v32, v32
    v_mfma_f32_16x16x32_bf16 v[52:55], a[64:67], a[8:11], v[64:67]
    ds_read_b64_tr_b16 a[98:99], v16 offset:4096
    v_exp_f32 v33, v33
    v_mfma_f32_16x16x32_bf16 v[40:43], a[52:55], a[20:23], v[40:43]
    ds_read_b64_tr_b16 a[100:101], v17
    v_exp_f32 v34, v34
    v_mfma_f32_16x16x32_bf16 v[52:55], a[68:71], a[20:23], v[52:55]
    ds_read_b64_tr_b16 a[102:103], v17 offset:4096
    v_exp_f32 v35, v35
    v_mfma_f32_16x16x32_bf16 v[40:43], a[56:59], a[32:35], v[40:43]
    ds_read_b64_tr_b16 a[104:105], v18
    v_cvt_pk_bf16_f32 v68, v32, v33
    v_mfma_f32_16x16x32_bf16 v[52:55], a[72:75], a[32:35], v[52:55]
    ds_read_b64_tr_b16 a[106:107], v18 offset:4096
    v_cvt_pk_bf16_f32 v69, v34, v35
    v_mfma_f32_16x16x32_bf16 v[40:43], a[60:63], a[44:47], v[40:43]
    ds_read_b64_tr_b16 a[108:109], v19
    v_exp_f32 v44, v44
    v_mfma_f32_16x16x32_bf16 v[52:55], a[76:79], a[44:47], v[52:55]
    ds_read_b64_tr_b16 a[110:111], v19 offset:4096
    v_exp_f32 v45, v45
    v_exp_f32 v46, v46
    v_exp_f32 v47, v47
    v_cvt_pk_bf16_f32 v70, v44, v45
    v_cvt_pk_bf16_f32 v71, v46, v47
    v_max3_f32 v194, v36, v37, v38
    v_max3_f32 v195, v39, v48, v49
    v_max3_f32 v195, v195, v50, v51
    v_max_f32 v194, v194, v195
    v_cmp_lt_f32 vcc, 0x41000000, v194
    s_nop 3
    s_cbranch_vccnz L_rare_10
L_back_11:
    s_waitcnt lgkmcnt(14)
    v_mfma_f32_16x16x32_bf16 v[80:83], a[80:83], v[68:71], v[80:83]
    s_mov_b32 m0, s55
    s_nop 0
    buffer_load_dwordx4 v2, s[24:27], s54 offen offset:0 nt lds
    s_waitcnt lgkmcnt(12)
    v_mfma_f32_16x16x32_bf16 v[92:95], a[84:87], v[68:71], v[92:95]
    v_exp_f32 v36, v36
    s_waitcnt lgkmcnt(10)
    v_mfma_f32_16x16x32_bf16 v[104:107], a[88:91], v[68:71], v[104:107]
    v_exp_f32 v37, v37
    s_waitcnt lgkmcnt(8)
    v_mfma_f32_16x16x32_bf16 v[116:119], a[92:95], v[68:71], v[116:119]
    v_exp_f32 v38, v38
    s_waitcnt lgkmcnt(6)
    v_mfma_f32_16x16x32_bf16 v[128:131], a[96:99], v[68:71], v[128:131]
    buffer_load_dwordx4 v3, s[24:27], s54 offen offset:1024 nt lds
    s_waitcnt lgkmcnt(4)
    v_mfma_f32_16x16x32_bf16 v[140:143], a[100:103], v[68:71], v[140:143]
    v_exp_f32 v39, v39
    s_waitcnt lgkmcnt(2)
    v_mfma_f32_16x16x32_bf16 v[152:155], a[104:107], v[68:71], v[152:155]
    v_cvt_pk_bf16_f32 v72, v36, v37
    v_cvt_pk_bf16_f32 v73, v38, v39
    s_waitcnt lgkmcnt(0)
    v_mfma_f32_16x16x32_bf16 v[164:167], a[108:111], v[68:71], v[164:167]
    v_exp_f32 v48, v48
    v_mfma_f32_16x16x32_bf16 v[176:179], v[188:191], v[68:71], v[176:179]
    buffer_load_dwordx4 v4, s[24:27], s54 offen offset:2048 nt lds
    v_exp_f32 v49, v49
    v_exp_f32 v50, v50
    v_exp_f32 v51, v51
    v_cvt_pk_bf16_f32 v74, v48, v49
    v_cvt_pk_bf16_f32 v75, v50, v51
    v_max3_f32 v196, v40, v41, v42
    v_max3_f32 v197, v43, v52, v53
    v_max3_f32 v197, v197, v54, v55
    v_max_f32 v196, v196, v197
    v_cmp_lt_f32 vcc, 0x41000000, v196
    buffer_load_dwordx4 v5, s[24:27], s54 offen offset:3072 nt lds
    s_add_u32 s54, s54, 16384
    s_add_u32 s55, s55, 32768
    s_cmp_ge_u32 s55, 98304
    s_cselect_b32 s60, 98304, 0
    s_sub_u32 s55, s55, s60
    s_cbranch_vccnz L_rare_12
L_back_13:
    v_mfma_f32_16x16x32_bf16 v[84:87], a[80:83], v[72:75], v[84:87]
    v_exp_f32 v40, v40
    v_mfma_f32_16x16x32_bf16 v[96:99], a[84:87], v[72:75], v[96:99]
    v_exp_f32 v41, v41
    v_mfma_f32_16x16x32_bf16 v[108:111], a[88:91], v[72:75], v[108:111]
    v_exp_f32 v42, v42
    v_mfma_f32_16x16x32_bf16 v[120:123], a[92:95], v[72:75], v[120:123]
    v_exp_f32 v43, v43
    v_mfma_f32_16x16x32_bf16 v[132:135], a[96:99], v[72:75], v[132:135]
    v_cvt_pk_bf16_f32 v76, v40, v41
    v_cvt_pk_bf16_f32 v77, v42, v43
    v_mfma_f32_16x16x32_bf16 v[144:147], a[100:103], v[72:75], v[144:147]
    v_exp_f32 v52, v52
    v_mfma_f32_16x16x32_bf16 v[156:159], a[104:107], v[72:75], v[156:159]
    v_exp_f32 v53, v53
    v_mfma_f32_16x16x32_bf16 v[168:171], a[108:111], v[72:75], v[168:171]
    v_exp_f32 v54, v54
    v_mfma_f32_16x16x32_bf16 v[180:183], v[188:191], v[72:75], v[180:183]
    v_exp_f32 v55, v55
    v_cvt_pk_bf16_f32 v78, v52, v53
    v_cvt_pk_bf16_f32 v79, v54, v55
    s_add_u32 s65, s65, 32768
    s_cmp_ge_u32 s65, 98304
    v_mfma_f32_16x16x32_bf16 v[88:91], a[80:83], v[76:79], v[88:91]
    s_cselect_b32 s59, 98304, 0
    s_sub_u32 s65, s65, s59
    v_mfma_f32_16x16x32_bf16 v[100:103], a[84:87], v[76:79], v[100:103]
    s_sub_u32 s67, 32768, s59
    v_add_u32 v8, s67, v8
    v_mfma_f32_16x16x32_bf16 v[112:115], a[88:91], v[76:79], v[112:115]
    v_add_u32 v9, s67, v9
    v_add_u32 v10, s67, v10
    v_mfma_f32_16x16x32_bf16 v[124:127], a[92:95], v[76:79], v[124:127]
    v_add_u32 v11, s67, v11
    v_add_u32 v12, s67, v12
    v_mfma_f32_16x16x32_bf16 v[136:139], a[96:99], v[76:79], v[136:139]
    v_add_u32 v13, s67, v13
    v_add_u32 v14, s67, v14
    v_mfma_f32_16x16x32_bf16 v[148:151], a[100:103], v[76:79], v[148:151]
    v_add_u32 v15, s67, v15
    v_add_u32 v16, s67, v16
    v_mfma_f32_16x16x32_bf16 v[160:163], a[104:107], v[76:79], v[160:163]
    v_add_u32 v17, s67, v17
    v_add_u32 v18, s67, v18
    v_mfma_f32_16x16x32_bf16 v[172:175], a[108:111], v[76:79], v[172:175]
    v_add_u32 v19, s67, v19
    v_mfma_f32_16x16x32_bf16 v[184:187], v[188:191], v[76:79], v[184:187]
    s_sub_u32 s53, s53, 1
    s_cmp_lg_u32 s53, 0
    s_cbranch_scc1 L_loop_3
    v_lshrrev_b32 v26, 4, v0
    v_and_b32 v27, 15, v0
    v_xor_b32 v28, v26, v27
    v_lshlrev_b32 v28, 4, v28
    v_lshl_add_u32 v28, v27, 8, v28
    s_mul_i32 s57, s49, 12288
    s_add_u32 s57, s57, 139264
    v_add_u32 v192, s57, v28
    v_xor_b32 v193, 64, v192
    v_xor_b32 v194, 128, v192
    v_xor_b32 v195, 192, v192
    ds_read_b128 a[0:3], v192 offset:0
    v_lshrrev_b32 v198, 2, v0
    v_lshlrev_b32 v198, 10, v198
    v_and_b32 v199, 1, v0
    ds_read_b128 a[4:7], v192 offset:4096
    v_lshl_add_u32 v198, v199, 7, v198
    s_lshl_b32 s57, s84, 9
    s_lshl_b32 s58, s87, 6
    ds_read_b128 a[8:11], v192 offset:8192
    s_add_u32 s57, s57, s58
    s_lshl_b32 s58, s48, 4
    s_add_u32 s57, s57, s58
    ds_read_b128 a[12:15], v193 offset:0
    s_lshl_b32 s57, s57, 10
    s_lshl_b32 s58, s85, 8
    s_add_u32 s57, s57, s58
    ds_read_b128 a[16:19], v193 offset:4096
    buffer_load_dword v199, v198, s[36:39], s57 offen
    ds_read_b128 a[20:23], v193 offset:8192
    ds_read_b128 a[24:27], v194 offset:0
    ds_read_b128 a[28:31], v194 offset:4096
    ds_read_b128 a[32:35], v194 offset:8192
    ds_read_b128 a[36:39], v195 offset:0
    ds_read_b128 a[40:43], v195 offset:4096
    ds_read_b128 a[44:47], v195 offset:8192
    s_waitcnt vmcnt(5)
    s_waitcnt lgkmcnt(0)
    s_barrier
    s_mov_b32 m0, s93
    s_nop 0
    buffer_load_dwordx4 v6, s[28:31], s92 offen offset:0 nt lds
    s_mul_i32 s57, s48, 12288
    v_mov_b32 v192, v56
    v_mov_b32 v195, v176
    v_mov_b32 v193, v60
    v_mov_b32 v196, v180
    v_mov_b32 v194, v64
    v_mov_b32 v197, v184
    v_lshrrev_b32 v31, 1, v23
    buffer_load_dwordx4 v7, s[28:31], s92 offen offset:1024 nt lds
    buffer_load_dwordx4 v6, s[28:31], s92 offen offset:2048 nt lds
    buffer_load_dwordx4 v7, s[28:31], s92 offen offset:3072 nt lds
    s_add_u32 s92, s92, 16384
    s_add_u32 s93, s93, 32768
    s_cmp_ge_u32 s93, 98304
    s_cselect_b32 s60, 98304, 0
    s_sub_u32 s93, s93, s60
    s_mov_b32 m0, s55
    s_nop 0
    buffer_load_dwordx4 v2, s[24:27], s54 offen offset:0 nt lds
    buffer_load_dwordx4 v3, s[24:27], s54 offen offset:1024 nt lds
    buffer_load_dwordx4 v4, s[24:27], s54 offen offset:2048 nt lds
    buffer_load_dwordx4 v5, s[24:27], s54 offen offset:3072 nt lds
    s_add_u32 s54, s54, 16384
    s_add_u32 s55, s55, 32768
    s_cmp_ge_u32 s55, 98304
    s_cselect_b32 s60, 98304, 0
    s_sub_u32 s55, s55, s60
    s_add_u32 s57, s57, 98304
    v_add_u32 v30, s57, v23
    ds_write_b128 v30, v[128:131] offset:0
    s_lshl_b32 s58, s48, 11
    s_add_u32 s58, s58, 147456
    v_add_u32 v31, s58, v31
    ds_write_b128 v30, v[132:135] offset:1024
    ds_write_b128 v30, v[136:139] offset:2048
    ds_write_b128 v30, v[140:143] offset:3072
    ds_write_b128 v30, v[144:147] offset:4096
    ds_write_b128 v30, v[148:151] offset:5120
    ds_write_b128 v30, v[152:155] offset:6144
    ds_write_b128 v30, v[156:159] offset:7168
    ds_write_b128 v30, v[160:163] offset:8192
    ds_write_b128 v30, v[164:167] offset:9216
    ds_write_b128 v30, v[168:171] offset:10240
    ds_write_b128 v30, v[172:175] offset:11264
    ds_write_b64 v31, v[192:193] offset:0
    ds_write_b64 v31, v[194:195] offset:512
    ds_write_b64 v31, v[196:197] offset:1024
    s_waitcnt lgkmcnt(0)
    s_barrier
    s_xor_b32 s59, s48, 1
    s_mul_i32 s57, s59, 12288
    s_add_u32 s57, s57, 98304
    v_add_u32 v30, s57, v23
    v_lshrrev_b32 v31, 1, v23
    s_lshl_b32 s58, s59, 11
    s_add_u32 s58, s58, 147456
    v_add_u32 v31, s58, v31
    ds_read_b64 v[200:201], v31 offset:0
    s_lshl_b32 s57, s52, 5
    ds_read_b64 v[202:203], v31 offset:512
    s_add_u32 s57, s57, s51
    ds_read_b64 v[204:205], v31 offset:1024
    s_lshl_b32 s57, s57, 1
    ds_read_b128 v[208:211], v30 offset:0
    s_add_u32 s57, s57, s50
    s_mul_i32 s57, s57, 12288
    s_mul_i32 s58, s49, 3072
    ds_read_b128 v[220:223], v30 offset:3072
    s_add_u32 s57, s57, s58
    s_add_u32 s58, s57, 6144
    v_lshrrev_b32 v26, 4, v0
    ds_read_b128 v[232:235], v30 offset:6144
    v_and_b32 v27, 15, v0
    v_lshlrev_b32 v28, 1, v26
    v_xor_b32 v28, v27, v28
    ds_read_b128 v[244:247], v30 offset:9216
    v_lshlrev_b32 v28, 4, v28
    v_lshl_add_u32 v20, v26, 10, v28
    v_xor_b32 v21, 0x80, v20
    ds_read_b128 v[212:215], v30 offset:1024
    s_waitcnt lgkmcnt(7)
    v_min_f32 v32, v56, v200
    v_sub_f32 v33, v32, v56
    ds_read_b128 v[224:227], v30 offset:4096
    v_sub_f32 v34, v32, v200
    v_exp_f32 v33, v33
    ds_read_b128 v[236:239], v30 offset:7168
    v_exp_f32 v34, v34
    v_mul_f32 v35, v33, v176
    ds_read_b128 v[248:251], v30 offset:10240
    s_waitcnt lgkmcnt(9)
    v_fmac_f32 v35, v34, v203
    v_rcp_f32 v35, v35
    ds_read_b128 v[216:219], v30 offset:2048
    v_mul_f32 v33, v33, v35
    v_mul_f32 v34, v34, v35
    v_mul_f32 v80, v33, v80
    ds_read_b128 v[228:231], v30 offset:5120
    s_waitcnt lgkmcnt(9)
    v_fmac_f32 v80, v34, v208
    v_mul_f32 v81, v33, v81
    v_fmac_f32 v81, v34, v209
    ds_read_b128 v[240:243], v30 offset:8192
    v_mul_f32 v82, v33, v82
    v_fmac_f32 v82, v34, v210
    v_mul_f32 v83, v33, v83
    ds_read_b128 v[252:255], v30 offset:11264
    v_fmac_f32 v83, v34, v211
    v_mul_f32 v92, v33, v92
    s_waitcnt lgkmcnt(10)
    v_fmac_f32 v92, v34, v220
    v_mul_f32 v93, v33, v93
    v_fmac_f32 v93, v34, v221
    v_mul_f32 v94, v33, v94
    v_fmac_f32 v94, v34, v222
    v_mul_f32 v95, v33, v95
    v_fmac_f32 v95, v34, v223
    v_cvt_pk_bf16_f32 v208, v80, v81
    v_cvt_pk_bf16_f32 v209, v82, v83
    v_cvt_pk_bf16_f32 v210, v92, v93
    v_cvt_pk_bf16_f32 v211, v94, v95
    buffer_store_dwordx4 v[208:211], v23, s[40:43], s57 offen offset:0 sc1
    v_mul_f32 v104, v33, v104
    s_waitcnt lgkmcnt(9)
    v_fmac_f32 v104, v34, v232
    v_mul_f32 v105, v33, v105
    v_fmac_f32 v105, v34, v233
    v_mul_f32 v106, v33, v106
    v_fmac_f32 v106, v34, v234
    v_mul_f32 v107, v33, v107
    v_fmac_f32 v107, v34, v235
    v_mul_f32 v116, v33, v116
    s_waitcnt lgkmcnt(8)
    v_fmac_f32 v116, v34, v244
    v_mul_f32 v117, v33, v117
    v_fmac_f32 v117, v34, v245
    v_mul_f32 v118, v33, v118
    v_fmac_f32 v118, v34, v246
    v_mul_f32 v119, v33, v119
    v_fmac_f32 v119, v34, v247
    v_cvt_pk_bf16_f32 v232, v104, v105
    v_cvt_pk_bf16_f32 v233, v106, v107
    v_cvt_pk_bf16_f32 v234, v116, v117
    v_cvt_pk_bf16_f32 v235, v118, v119
    buffer_store_dwordx4 v[232:235], v23, s[40:43], s58 offen offset:0 sc1
    v_min_f32 v36, v60, v201
    v_sub_f32 v37, v36, v60
    v_sub_f32 v38, v36, v201
    v_exp_f32 v37, v37
    v_exp_f32 v38, v38
    v_mul_f32 v39, v37, v180
    v_fmac_f32 v39, v38, v204
    v_rcp_f32 v39, v39
    v_min_f32 v40, v64, v202
    v_mul_f32 v37, v37, v39
    v_mul_f32 v38, v38, v39
    v_mul_f32 v84, v37, v84
    s_waitcnt lgkmcnt(7)
    v_fmac_f32 v84, v38, v212
    v_mul_f32 v85, v37, v85
    v_fmac_f32 v85, v38, v213
    v_mul_f32 v86, v37, v86
    v_fmac_f32 v86, v38, v214
    v_mul_f32 v87, v37, v87
    v_fmac_f32 v87, v38, v215
    v_mul_f32 v96, v37, v96
    s_waitcnt lgkmcnt(6)
    v_fmac_f32 v96, v38, v224
    v_mul_f32 v97, v37, v97
    v_fmac_f32 v97, v38, v225
    v_mul_f32 v98, v37, v98
    v_fmac_f32 v98, v38, v226
    v_mul_f32 v99, v37, v99
    v_fmac_f32 v99, v38, v227
    v_cvt_pk_bf16_f32 v212, v84, v85
    v_cvt_pk_bf16_f32 v213, v86, v87
    v_cvt_pk_bf16_f32 v214, v96, v97
    v_cvt_pk_bf16_f32 v215, v98, v99
    buffer_store_dwordx4 v[212:215], v23, s[40:43], s57 offen offset:1024 sc1
    v_mul_f32 v108, v37, v108
    s_waitcnt lgkmcnt(5)
    v_fmac_f32 v108, v38, v236
    v_mul_f32 v109, v37, v109
    v_fmac_f32 v109, v38, v237
    v_mul_f32 v110, v37, v110
    v_fmac_f32 v110, v38, v238
    v_mul_f32 v111, v37, v111
    v_fmac_f32 v111, v38, v239
    v_mul_f32 v120, v37, v120
    s_waitcnt lgkmcnt(4)
    v_fmac_f32 v120, v38, v248
    v_mul_f32 v121, v37, v121
    v_fmac_f32 v121, v38, v249
    v_mul_f32 v122, v37, v122
    v_fmac_f32 v122, v38, v250
    v_mul_f32 v123, v37, v123
    v_fmac_f32 v123, v38, v251
    v_cvt_pk_bf16_f32 v236, v108, v109
    v_cvt_pk_bf16_f32 v237, v110, v111
    v_cvt_pk_bf16_f32 v238, v120, v121
    v_cvt_pk_bf16_f32 v239, v122, v123
    buffer_store_dwordx4 v[236:239], v23, s[40:43], s58 offen offset:1024 sc1
    v_sub_f32 v41, v40, v64
    v_sub_f32 v42, v40, v202
    v_exp_f32 v41, v41
    v_exp_f32 v42, v42
    v_mul_f32 v43, v41, v184
    v_fmac_f32 v43, v42, v205
    v_rcp_f32 v43, v43
    s_nop 0
    v_mul_f32 v41, v41, v43
    v_mul_f32 v42, v42, v43
    v_mul_f32 v88, v41, v88
    s_waitcnt lgkmcnt(3)
    v_fmac_f32 v88, v42, v216
    v_mul_f32 v89, v41, v89
    v_fmac_f32 v89, v42, v217
    v_mul_f32 v90, v41, v90
    v_fmac_f32 v90, v42, v218
    v_mul_f32 v91, v41, v91
    v_fmac_f32 v91, v42, v219
    v_mul_f32 v100, v41, v100
    s_waitcnt lgkmcnt(2)
    v_fmac_f32 v100, v42, v228
    v_mul_f32 v101, v41, v101
    v_fmac_f32 v101, v42, v229
    v_mul_f32 v102, v41, v102
    v_fmac_f32 v102, v42, v230
    v_mul_f32 v103, v41, v103
    v_fmac_f32 v103, v42, v231
    v_cvt_pk_bf16_f32 v216, v88, v89
    v_cvt_pk_bf16_f32 v217, v90, v91
    v_cvt_pk_bf16_f32 v218, v100, v101
    v_cvt_pk_bf16_f32 v219, v102, v103
    buffer_store_dwordx4 v[216:219], v23, s[40:43], s57 offen offset:2048 sc1
    v_mul_f32 v112, v41, v112
    s_waitcnt lgkmcnt(1)
    v_fmac_f32 v112, v42, v240
    v_mul_f32 v113, v41, v113
    v_fmac_f32 v113, v42, v241
    v_mul_f32 v114, v41, v114
    v_fmac_f32 v114, v42, v242
    v_mul_f32 v115, v41, v115
    v_fmac_f32 v115, v42, v243
    v_mul_f32 v124, v41, v124
    s_waitcnt lgkmcnt(0)
    v_fmac_f32 v124, v42, v252
    v_mul_f32 v125, v41, v125
    v_fmac_f32 v125, v42, v253
    v_mul_f32 v126, v41, v126
    v_fmac_f32 v126, v42, v254
    v_mul_f32 v127, v41, v127
    v_fmac_f32 v127, v42, v255
    v_cvt_pk_bf16_f32 v240, v112, v113
    v_cvt_pk_bf16_f32 v241, v114, v115
    v_cvt_pk_bf16_f32 v242, v124, v125
    v_cvt_pk_bf16_f32 v243, v126, v127
    buffer_store_dwordx4 v[240:243], v23, s[40:43], s58 offen offset:2048 sc1
    s_waitcnt lgkmcnt(0)
    s_mov_b32 s56, 0x8000000
    s_mov_b32 s52, s82
    s_barrier
    s_add_u32 s74, s85, 0
    s_add_u32 s76, s87, 0
    s_and_b32 s74, s74, 3
    s_lshl_b32 s74, s74, 2
    s_and_b32 s76, s76, 3
    s_add_u32 s74, s74, s76
    s_lshl_b32 s74, s74, 15
    s_add_u32 s74, s74, s72
    s_lshl_b32 s75, s48, 11
    s_add_u32 m0, s75, 98304
    s_nop 0
    buffer_load_dwordx4 v20, s[36:39], s74 offen  lds
    s_add_u32 s74, s74, 4096
    s_add_u32 m0, s75, 99328
    ds_read_b128 a[48:51], v8 offset:0
    ds_read_b128 a[64:67], v8 offset:4096
    ds_read_b128 a[52:55], v9 offset:0
    buffer_load_dwordx4 v21, s[36:39], s74 offen  lds
    s_add_u32 s74, s85, 0
    s_add_u32 s76, s87, 1
    s_and_b32 s74, s74, 3
    s_lshl_b32 s74, s74, 2
    s_and_b32 s76, s76, 3
    s_add_u32 s74, s74, s76
    s_lshl_b32 s74, s74, 15
    s_add_u32 s74, s74, s72
    s_lshl_b32 s75, s48, 11
    s_add_u32 m0, s75, 106496
    s_waitcnt lgkmcnt(2)
    v_mfma_f32_16x16x32_bf16 v[32:35], a[48:51], a[0:3], 0
    ds_read_b128 a[68:71], v9 offset:4096
    buffer_load_dwordx4 v20, s[36:39], s74 offen  lds
    s_waitcnt lgkmcnt(2)
    v_mfma_f32_16x16x32_bf16 v[44:47], a[64:67], a[0:3], 0
    s_add_u32 s74, s74, 4096
    s_add_u32 m0, s75, 107520
    s_waitcnt lgkmcnt(1)
    v_mfma_f32_16x16x32_bf16 v[32:35], a[52:55], a[12:15], v[32:35]
    ds_read_b128 a[56:59], v10 offset:0
    v_mfma_f32_16x16x32_bf16 v[36:39], a[48:51], a[4:7], 0
    ds_read_b128 a[72:75], v10 offset:4096
    v_mfma_f32_16x16x32_bf16 v[48:51], a[64:67], a[4:7], 0
    buffer_load_dwordx4 v21, s[36:39], s74 offen  lds
    v_mfma_f32_16x16x32_bf16 v[36:39], a[52:55], a[16:19], v[36:39]
    s_add_u32 s74, s85, 0
    s_add_u32 s76, s87, 2
    s_waitcnt lgkmcnt(2)
    v_mfma_f32_16x16x32_bf16 v[44:47], a[68:71], a[12:15], v[44:47]
    s_and_b32 s74, s74, 3
    s_lshl_b32 s74, s74, 2
    v_mfma_f32_16x16x32_bf16 v[48:51], a[68:71], a[16:19], v[48:51]
    s_and_b32 s76, s76, 3
    s_add_u32 s74, s74, s76
    v_mfma_f32_16x16x32_bf16 v[40:43], a[48:51], a[8:11], 0
    s_lshl_b32 s74, s74, 15
    s_add_u32 s74, s74, s72
    s_waitcnt lgkmcnt(1)
    v_mfma_f32_16x16x32_bf16 v[32:35], a[56:59], a[24:27], v[32:35]
    s_lshl_b32 s75, s48, 11
    s_add_u32 m0, s75, 114688
    s_waitcnt lgkmcnt(0)
    v_mfma_f32_16x16x32_bf16 v[44:47], a[72:75], a[24:27], v[44:47]
    buffer_load_dwordx4 v20, s[36:39], s74 offen  lds
    v_mfma_f32_16x16x32_bf16 v[36:39], a[56:59], a[28:31], v[36:39]
    s_add_u32 s74, s74, 4096
    s_add_u32 m0, s75, 115712
    v_mfma_f32_16x16x32_bf16 v[48:51], a[72:75], a[28:31], v[48:51]
    ds_read_b128 a[60:63], v11 offset:0
    v_mfma_f32_16x16x32_bf16 v[52:55], a[64:67], a[8:11], 0
    ds_read_b128 a[76:79], v11 offset:4096
    v_mfma_f32_16x16x32_bf16 v[40:43], a[52:55], a[20:23], v[40:43]
    buffer_load_dwordx4 v21, s[36:39], s74 offen  lds
    v_mfma_f32_16x16x32_bf16 v[52:55], a[68:71], a[20:23], v[52:55]
    s_add_u32 s74, s85, 0
    s_add_u32 s76, s87, 3
    v_mfma_f32_16x16x32_bf16 v[40:43], a[56:59], a[32:35], v[40:43]
    s_and_b32 s74, s74, 3
    s_lshl_b32 s74, s74, 2
    v_mfma_f32_16x16x32_bf16 v[52:55], a[72:75], a[32:35], v[52:55]
    s_and_b32 s76, s76, 3
    s_add_u32 s74, s74, s76
    s_lshl_b32 s74, s74, 15
    s_add_u32 s74, s74, s72
    s_waitcnt lgkmcnt(1)
    v_mfma_f32_16x16x32_bf16 v[32:35], a[60:63], a[36:39], v[32:35]
    s_lshl_b32 s75, s48, 11
    s_add_u32 m0, s75, 122880
    s_waitcnt lgkmcnt(0)
    v_mfma_f32_16x16x32_bf16 v[44:47], a[76:79], a[36:39], v[44:47]
    buffer_load_dwordx4 v20, s[36:39], s74 offen  lds
    v_mfma_f32_16x16x32_bf16 v[36:39], a[60:63], a[40:43], v[36:39]
    s_add_u32 s74, s74, 4096
    s_add_u32 m0, s75, 123904
    v_mfma_f32_16x16x32_bf16 v[48:51], a[76:79], a[40:43], v[48:51]
    ds_read_b64_tr_b16 a[80:81], v12
    v_max3_f32 v192, v32, v33, v34
    v_mfma_f32_16x16x32_bf16 v[40:43], a[60:63], a[44:47], v[40:43]
    ds_read_b64_tr_b16 a[82:83], v12 offset:4096
    v_max3_f32 v193, v35, v44, v45
    v_mfma_f32_16x16x32_bf16 v[52:55], a[76:79], a[44:47], v[52:55]
    buffer_load_dwordx4 v21, s[36:39], s74 offen  lds
    s_add_u32 s74, s85, 1
    s_add_u32 s76, s87, 4
    s_and_b32 s74, s74, 3
    s_lshl_b32 s74, s74, 2
    s_and_b32 s76, s76, 3
    s_add_u32 s74, s74, s76
    s_lshl_b32 s74, s74, 15
    s_add_u32 s74, s74, s72
    s_lshl_b32 s75, s48, 11
    s_add_u32 m0, s75, 131072
    ds_read_b64_tr_b16 a[84:85], v13
    v_max3_f32 v193, v193, v46, v47
    ds_read_b64_tr_b16 a[86:87], v13 offset:4096
    v_max_f32 v192, v192, v193
    buffer_load_dwordx4 v20, s[36:39], s74 offen  lds
    s_add_u32 s74, s74, 4096
    s_add_u32 m0, s75, 132096
    ds_read_b64_tr_b16 a[88:89], v14
    v_mov_b32 v193, v192
    ds_read_b64_tr_b16 a[90:91], v14 offset:4096
    s_nop 0
    v_permlane16_swap_b32 v192, v193
    ds_read_b64_tr_b16 a[92:93], v15
    v_max_f32 v192, v192, v193
    ds_read_b64_tr_b16 a[94:95], v15 offset:4096
    v_mov_b32 v193, v192
    ds_read_b64_tr_b16 a[96:97], v16
    s_nop 0
    v_permlane32_swap_b32 v192, v193
    ds_read_b64_tr_b16 a[98:99], v16 offset:4096
    v_max_f32 v192, v192, v193
    buffer_load_dwordx4 v21, s[36:39], s74 offen  lds
    s_add_u32 s74, s85, 1
    s_add_u32 s76, s87, 5
    s_and_b32 s74, s74, 3
    s_lshl_b32 s74, s74, 2
    s_and_b32 s76, s76, 3
    s_add_u32 s74, s74, s76
    s_lshl_b32 s74, s74, 15
    s_add_u32 s74, s74, s72
    s_lshl_b32 s75, s48, 11
    s_add_u32 m0, s75, 139264
    ds_read_b64_tr_b16 a[100:101], v17
    v_sub_f32 v56, 0, v192
    ds_read_b64_tr_b16 a[102:103], v17 offset:4096
    v_sub_f32 v57, 0, v192
    buffer_load_dwordx4 v20, s[36:39], s74 offen  lds
    s_add_u32 s74, s74, 4096
    s_add_u32 m0, s75, 140288
    ds_read_b64_tr_b16 a[104:105], v18
    v_sub_f32 v58, 0, v192
    ds_read_b64_tr_b16 a[106:107], v18 offset:4096
    v_sub_f32 v59, 0, v192
    ds_read_b64_tr_b16 a[108:109], v19
    v_sub_f32 v32, v32, v192
    ds_read_b64_tr_b16 a[110:111], v19 offset:4096
    v_sub_f32 v33, v33, v192
    v_sub_f32 v34, v34, v192
    v_sub_f32 v35, v35, v192
    v_sub_f32 v44, v44, v192
    v_sub_f32 v45, v45, v192
    buffer_load_dwordx4 v21, s[36:39], s74 offen  lds
    s_add_u32 s74, s85, 1
    s_add_u32 s76, s87, 6
    s_and_b32 s74, s74, 3
    s_lshl_b32 s74, s74, 2
    s_and_b32 s76, s76, 3
    s_add_u32 s74, s74, s76
    s_lshl_b32 s74, s74, 15
    s_add_u32 s74, s74, s72
    s_lshl_b32 s75, s48, 11
    s_add_u32 m0, s75, 147456
    v_sub_f32 v46, v46, v192
    v_sub_f32 v47, v47, v192
    v_exp_f32 v32, v32
    buffer_load_dwordx4 v20, s[36:39], s74 offen  lds
    s_add_u32 s74, s74, 4096
    s_add_u32 m0, s75, 148480
    v_exp_f32 v33, v33
    v_exp_f32 v34, v34
    v_exp_f32 v35, v35
    v_cvt_pk_bf16_f32 v68, v32, v33
    v_cvt_pk_bf16_f32 v69, v34, v35
    v_exp_f32 v44, v44
    v_exp_f32 v45, v45
    buffer_load_dwordx4 v21, s[36:39], s74 offen  lds
    s_add_u32 s74, s85, 1
    s_add_u32 s76, s87, 7
    s_and_b32 s74, s74, 3
    s_lshl_b32 s74, s74, 2
    s_and_b32 s76, s76, 3
    s_add_u32 s74, s74, s76
    s_lshl_b32 s74, s74, 15
    s_add_u32 s74, s74, s72
    s_lshl_b32 s75, s48, 11
    s_add_u32 m0, s75, 155648
    v_exp_f32 v46, v46
    v_exp_f32 v47, v47
    buffer_load_dwordx4 v20, s[36:39], s74 offen  lds
    s_add_u32 s74, s74, 4096
    s_add_u32 m0, s75, 156672
    v_cvt_pk_bf16_f32 v70, v44, v45
    v_cvt_pk_bf16_f32 v71, v46, v47
    v_max3_f32 v194, v36, v37, v38
    v_max3_f32 v195, v39, v48, v49
    s_waitcnt lgkmcnt(14)
    v_mfma_f32_16x16x32_bf16 v[80:83], a[80:83], v[68:71], 0
    v_max3_f32 v195, v195, v50, v51
    v_max_f32 v194, v194, v195
    s_waitcnt lgkmcnt(12)
    v_mfma_f32_16x16x32_bf16 v[92:95], a[84:87], v[68:71], 0
    v_mov_b32 v195, v194
    s_nop 1
    v_permlane16_swap_b32 v194, v195
    s_waitcnt lgkmcnt(10)
    v_mfma_f32_16x16x32_bf16 v[104:107], a[88:91], v[68:71], 0
    buffer_load_dwordx4 v21, s[36:39], s74 offen  lds
    s_waitcnt lgkmcnt(8)
    v_mfma_f32_16x16x32_bf16 v[116:119], a[92:95], v[68:71], 0
    v_max_f32 v194, v194, v195
    v_mov_b32 v195, v194
    s_waitcnt lgkmcnt(6)
    v_mfma_f32_16x16x32_bf16 v[128:131], a[96:99], v[68:71], 0
    v_permlane32_swap_b32 v194, v195
    v_max_f32 v194, v194, v195
    s_waitcnt lgkmcnt(4)
    v_mfma_f32_16x16x32_bf16 v[140:143], a[100:103], v[68:71], 0
    v_sub_f32 v60, 0, v194
    v_sub_f32 v61, 0, v194
    s_waitcnt lgkmcnt(2)
    v_mfma_f32_16x16x32_bf16 v[152:155], a[104:107], v[68:71], 0
    v_sub_f32 v62, 0, v194
    v_sub_f32 v63, 0, v194
    s_waitcnt lgkmcnt(0)
    v_mfma_f32_16x16x32_bf16 v[164:167], a[108:111], v[68:71], 0
    v_sub_f32 v36, v36, v194
    v_sub_f32 v37, v37, v194
    v_mfma_f32_16x16x32_bf16 v[176:179], v[188:191], v[68:71], 0
    v_sub_f32 v38, v38, v194
    v_sub_f32 v39, v39, v194
    v_sub_f32 v48, v48, v194
    v_sub_f32 v49, v49, v194
    v_sub_f32 v50, v50, v194
    v_sub_f32 v51, v51, v194
    v_exp_f32 v36, v36
    v_exp_f32 v37, v37
    v_exp_f32 v38, v38
    v_exp_f32 v39, v39
    v_cvt_pk_bf16_f32 v72, v36, v37
    v_cvt_pk_bf16_f32 v73, v38, v39
    v_exp_f32 v48, v48
    v_exp_f32 v49, v49
    v_exp_f32 v50, v50
    v_exp_f32 v51, v51
    v_cvt_pk_bf16_f32 v74, v48, v49
    v_cvt_pk_bf16_f32 v75, v50, v51
    v_max3_f32 v196, v40, v41, v42
    v_max3_f32 v197, v43, v52, v53
    v_mfma_f32_16x16x32_bf16 v[84:87], a[80:83], v[72:75], 0
    v_max3_f32 v197, v197, v54, v55
    v_max_f32 v196, v196, v197
    v_mfma_f32_16x16x32_bf16 v[96:99], a[84:87], v[72:75], 0
    v_mov_b32 v197, v196
    s_nop 1
    v_permlane16_swap_b32 v196, v197
    v_mfma_f32_16x16x32_bf16 v[108:111], a[88:91], v[72:75], 0
    v_max_f32 v196, v196, v197
    v_mov_b32 v197, v196
    v_mfma_f32_16x16x32_bf16 v[120:123], a[92:95], v[72:75], 0
    s_nop 0
    v_permlane32_swap_b32 v196, v197
    v_max_f32 v196, v196, v197
    v_mfma_f32_16x16x32_bf16 v[132:135], a[96:99], v[72:75], 0
    v_sub_f32 v64, 0, v196
    v_sub_f32 v65, 0, v196
    v_mfma_f32_16x16x32_bf16 v[144:147], a[100:103], v[72:75], 0
    v_sub_f32 v66, 0, v196
    v_sub_f32 v67, 0, v196
    v_mfma_f32_16x16x32_bf16 v[156:159], a[104:107], v[72:75], 0
    v_sub_f32 v40, v40, v196
    v_sub_f32 v41, v41, v196
    v_mfma_f32_16x16x32_bf16 v[168:171], a[108:111], v[72:75], 0
    v_sub_f32 v42, v42, v196
    v_sub_f32 v43, v43, v196
    v_mfma_f32_16x16x32_bf16 v[180:183], v[188:191], v[72:75], 0
    v_sub_f32 v52, v52, v196
    v_sub_f32 v53, v53, v196
    v_sub_f32 v54, v54, v196
    v_sub_f32 v55, v55, v196
    v_exp_f32 v40, v40
    v_exp_f32 v41, v41
    v_exp_f32 v42, v42
    v_exp_f32 v43, v43
    v_cvt_pk_bf16_f32 v76, v40, v41
    v_cvt_pk_bf16_f32 v77, v42, v43
    v_exp_f32 v52, v52
    v_exp_f32 v53, v53
    v_exp_f32 v54, v54
    v_exp_f32 v55, v55
    v_cvt_pk_bf16_f32 v78, v52, v53
    v_cvt_pk_bf16_f32 v79, v54, v55
    s_add_u32 s65, s65, 32768
    s_cmp_ge_u32 s65, 98304
    v_mfma_f32_16x16x32_bf16 v[88:91], a[80:83], v[76:79], 0
    s_cselect_b32 s59, 98304, 0
    s_sub_u32 s65, s65, s59
    v_mfma_f32_16x16x32_bf16 v[100:103], a[84:87], v[76:79], 0
    s_sub_u32 s67, 32768, s59
    v_add_u32 v8, s67, v8
    v_mfma_f32_16x16x32_bf16 v[112:115], a[88:91], v[76:79], 0
    v_add_u32 v9, s67, v9
    v_add_u32 v10, s67, v10
    v_mfma_f32_16x16x32_bf16 v[124:127], a[92:95], v[76:79], 0
    v_add_u32 v11, s67, v11
    v_add_u32 v12, s67, v12
    v_mfma_f32_16x16x32_bf16 v[136:139], a[96:99], v[76:79], 0
    v_add_u32 v13, s67, v13
    v_add_u32 v14, s67, v14
    v_mfma_f32_16x16x32_bf16 v[148:151], a[100:103], v[76:79], 0
    v_add_u32 v15, s67, v15
    v_add_u32 v16, s67, v16
    v_mfma_f32_16x16x32_bf16 v[160:163], a[104:107], v[76:79], 0
    v_add_u32 v17, s67, v17
    v_add_u32 v18, s67, v18
    v_mfma_f32_16x16x32_bf16 v[172:175], a[108:111], v[76:79], 0
    v_add_u32 v19, s67, v19
    v_mfma_f32_16x16x32_bf16 v[184:187], v[188:191], v[76:79], 0
    s_mov_b32 s53, 15
L_loop_14:
    s_cmp_eq_u32 s53, 2
    s_cselect_b32 s54, s56, s54
    s_cmp_eq_u32 s53, 1
    s_cselect_b32 s92, s56, s92
    s_waitcnt vmcnt(4)
    s_mov_b32 s60, 0xe38
    s_bitcmp1_b32 s60, s53
    s_cbranch_scc1 L_fd_15
L_fb_16:
    s_barrier
    s_mov_b32 s60, 0x3cf0
    s_bitcmp1_b32 s60, s53
    s_cbranch_scc1 L_fd_17
L_fb_18:
    s_mov_b32 m0, s93
    s_nop 0
    buffer_load_dwordx4 v6, s[28:31], s92 offen offset:0 nt lds
    s_waitcnt lgkmcnt(15)
    ds_read_b128 a[48:51], v8 offset:0
    ds_read_b128 a[64:67], v8 offset:4096
    ds_read_b128 a[52:55], v9 offset:0
    ds_read_b128 a[68:71], v9 offset:4096
    buffer_load_dwordx4 v7, s[28:31], s92 offen offset:1024 nt lds
    ds_read_b128 a[56:59], v10 offset:0
    ds_read_b128 a[72:75], v10 offset:4096
    ds_read_b128 a[60:63], v11 offset:0
    s_waitcnt lgkmcnt(6)
    v_mfma_f32_16x16x32_bf16 v[32:35], a[48:51], a[0:3], v[56:59]
    ds_read_b128 a[76:79], v11 offset:4096
    s_waitcnt lgkmcnt(6)
    v_mfma_f32_16x16x32_bf16 v[44:47], a[64:67], a[0:3], v[56:59]
    buffer_load_dwordx4 v6, s[28:31], s92 offen offset:2048 nt lds
    s_waitcnt lgkmcnt(5)
    v_mfma_f32_16x16x32_bf16 v[32:35], a[52:55], a[12:15], v[32:35]
    ds_read_b64_tr_b16 a[80:81], v12
    s_waitcnt lgkmcnt(5)
    v_mfma_f32_16x16x32_bf16 v[44:47], a[68:71], a[12:15], v[44:47]
    ds_read_b64_tr_b16 a[82:83], v12 offset:4096
    s_waitcnt lgkmcnt(5)
    v_mfma_f32_16x16x32_bf16 v[32:35], a[56:59], a[24:27], v[32:35]
    ds_read_b64_tr_b16 a[84:85], v13
    s_waitcnt lgkmcnt(5)
    v_mfma_f32_16x16x32_bf16 v[44:47], a[72:75], a[24:27], v[44:47]
    buffer_load_dwordx4 v7, s[28:31], s92 offen offset:3072 nt lds
    s_waitcnt lgkmcnt(4)
    v_mfma_f32_16x16x32_bf16 v[32:35], a[60:63], a[36:39], v[32:35]
    s_add_u32 s92, s92, 16384
    s_add_u32 s93, s93, 32768
    s_waitcnt lgkmcnt(3)
    v_mfma_f32_16x16x32_bf16 v[44:47], a[76:79], a[36:39], v[44:47]
    s_cmp_ge_u32 s93, 98304
    s_cselect_b32 s60, 98304, 0
    v_mfma_f32_16x16x32_bf16 v[36:39], a[48:51], a[4:7], v[60:63]
    s_sub_u32 s93, s93, s60
    ds_read_b64_tr_b16 a[86:87], v13 offset:4096
    v_mfma_f32_16x16x32_bf16 v[48:51], a[64:67], a[4:7], v[60:63]
    ds_read_b64_tr_b16 a[88:89], v14
    v_max3_f32 v192, v32, v33, v34
    v_mfma_f32_16x16x32_bf16 v[36:39], a[52:55], a[16:19], v[36:39]
    ds_read_b64_tr_b16 a[90:91], v14 offset:4096
    v_max3_f32 v193, v35, v44, v45
    v_mfma_f32_16x16x32_bf16 v[48:51], a[68:71], a[16:19], v[48:51]
    ds_read_b64_tr_b16 a[92:93], v15
    v_max3_f32 v193, v193, v46, v47
    v_mfma_f32_16x16x32_bf16 v[36:39], a[56:59], a[28:31], v[36:39]
    ds_read_b64_tr_b16 a[94:95], v15 offset:4096
    v_max_f32 v192, v192, v193
    v_mfma_f32_16x16x32_bf16 v[48:51], a[72:75], a[28:31], v[48:51]
    v_cmp_lt_f32 vcc, 0x41000000, v192
    v_mfma_f32_16x16x32_bf16 v[36:39], a[60:63], a[40:43], v[36:39]
    v_mfma_f32_16x16x32_bf16 v[48:51], a[76:79], a[40:43], v[48:51]
    s_nop 1
    s_cbranch_vccnz L_rare_19
L_back_20:
    v_mfma_f32_16x16x32_bf16 v[40:43], a[48:51], a[8:11], v[64:67]
    ds_read_b64_tr_b16 a[96:97], v16
    v_exp_f32 v32, v32
    v_mfma_f32_16x16x32_bf16 v[52:55], a[64:67], a[8:11], v[64:67]
    ds_read_b64_tr_b16 a[98:99], v16 offset:4096
    v_exp_f32 v33, v33
    v_mfma_f32_16x16x32_bf16 v[40:43], a[52:55], a[20:23], v[40:43]
    ds_read_b64_tr_b16 a[100:101], v17
    v_exp_f32 v34, v34
    v_mfma_f32_16x16x32_bf16 v[52:55], a[68:71], a[20:23], v[52:55]
    ds_read_b64_tr_b16 a[102:103], v17 offset:4096
    v_exp_f32 v35, v35
    v_mfma_f32_16x16x32_bf16 v[40:43], a[56:59], a[32:35], v[40:43]
    ds_read_b64_tr_b16 a[104:105], v18
    v_cvt_pk_bf16_f32 v68, v32, v33
    v_mfma_f32_16x16x32_bf16 v[52:55], a[72:75], a[32:35], v[52:55]
    ds_read_b64_tr_b16 a[106:107], v18 offset:4096
    v_cvt_pk_bf16_f32 v69, v34, v35
    v_mfma_f32_16x16x32_bf16 v[40:43], a[60:63], a[44:47], v[40:43]
    ds_read_b64_tr_b16 a[108:109], v19
    v_exp_f32 v44, v44
    v_mfma_f32_16x16x32_bf16 v[52:55], a[76:79], a[44:47], v[52:55]
    ds_read_b64_tr_b16 a[110:111], v19 offset:4096
    v_exp_f32 v45, v45
    v_exp_f32 v46, v46
    v_exp_f32 v47, v47
    v_cvt_pk_bf16_f32 v70, v44, v45
    v_cvt_pk_bf16_f32 v71, v46, v47
    v_max3_f32 v194, v36, v37, v38
    v_max3_f32 v195, v39, v48, v49
    v_max3_f32 v195, v195, v50, v51
    v_max_f32 v194, v194, v195
    v_cmp_lt_f32 vcc, 0x41000000, v194
    s_nop 3
    s_cbranch_vccnz L_rare_21
L_back_22:
    s_waitcnt lgkmcnt(14)
    v_mfma_f32_16x16x32_bf16 v[80:83], a[80:83], v[68:71], v[80:83]
    s_mov_b32 m0, s55
    s_nop 0
    buffer_load_dwordx4 v2, s[24:27], s54 offen offset:0 nt lds
    s_waitcnt lgkmcnt(12)
    v_mfma_f32_16x16x32_bf16 v[92:95], a[84:87], v[68:71], v[92:95]
    v_exp_f32 v36, v36
    s_waitcnt lgkmcnt(10)
    v_mfma_f32_16x16x32_bf16 v[104:107], a[88:91], v[68:71], v[104:107]
    v_exp_f32 v37, v37
    s_waitcnt lgkmcnt(8)
    v_mfma_f32_16x16x32_bf16 v[116:119], a[92:95], v[68:71], v[116:119]
    v_exp_f32 v38, v38
    s_waitcnt lgkmcnt(6)
    v_mfma_f32_16x16x32_bf16 v[128:131], a[96:99], v[68:71], v[128:131]
    buffer_load_dwordx4 v3, s[24:27], s54 offen offset:1024 nt lds
    s_waitcnt lgkmcnt(4)
    v_mfma_f32_16x16x32_bf16 v[140:143], a[100:103], v[68:71], v[140:143]
    v_exp_f32 v39, v39
    s_waitcnt lgkmcnt(2)
    v_mfma_f32_16x16x32_bf16 v[152:155], a[104:107], v[68:71], v[152:155]
    v_cvt_pk_bf16_f32 v72, v36, v37
    v_cvt_pk_bf16_f32 v73, v38, v39
    s_waitcnt lgkmcnt(0)
    v_mfma_f32_16x16x32_bf16 v[164:167], a[108:111], v[68:71], v[164:167]
    v_exp_f32 v48, v48
    v_mfma_f32_16x16x32_bf16 v[176:179], v[188:191], v[68:71], v[176:179]
    buffer_load_dwordx4 v4, s[24:27], s54 offen offset:2048 nt lds
    v_exp_f32 v49, v49
    v_exp_f32 v50, v50
    v_exp_f32 v51, v51
    v_cvt_pk_bf16_f32 v74, v48, v49
    v_cvt_pk_bf16_f32 v75, v50, v51
    v_max3_f32 v196, v40, v41, v42
    v_max3_f32 v197, v43, v52, v53
    v_max3_f32 v197, v197, v54, v55
    v_max_f32 v196, v196, v197
    v_cmp_lt_f32 vcc, 0x41000000, v196
    buffer_load_dwordx4 v5, s[24:27], s54 offen offset:3072 nt lds
    s_add_u32 s54, s54, 16384
    s_add_u32 s55, s55, 32768
    s_cmp_ge_u32 s55, 98304
    s_cselect_b32 s60, 98304, 0
    s_sub_u32 s55, s55, s60
    s_cbranch_vccnz L_rare_23
L_back_24:
    v_mfma_f32_16x16x32_bf16 v[84:87], a[80:83], v[72:75], v[84:87]
    v_exp_f32 v40, v40
    v_mfma_f32_16x16x32_bf16 v[96:99], a[84:87], v[72:75], v[96:99]
    v_exp_f32 v41, v41
    v_mfma_f32_16x16x32_bf16 v[108:111], a[88:91], v[72:75], v[108:111]
    v_exp_f32 v42, v42
    v_mfma_f32_16x16x32_bf16 v[120:123], a[92:95], v[72:75], v[120:123]
    v_exp_f32 v43, v43
    v_mfma_f32_16x16x32_bf16 v[132:135], a[96:99], v[72:75], v[132:135]
    v_cvt_pk_bf16_f32 v76, v40, v41
    v_cvt_pk_bf16_f32 v77, v42, v43
    v_mfma_f32_16x16x32_bf16 v[144:147], a[100:103], v[72:75], v[144:147]
    v_exp_f32 v52, v52
    v_mfma_f32_16x16x32_bf16 v[156:159], a[104:107], v[72:75], v[156:159]
    v_exp_f32 v53, v53
    v_mfma_f32_16x16x32_bf16 v[168:171], a[108:111], v[72:75], v[168:171]
    v_exp_f32 v54, v54
    v_mfma_f32_16x16x32_bf16 v[180:183], v[188:191], v[72:75], v[180:183]
    v_exp_f32 v55, v55
    v_cvt_pk_bf16_f32 v78, v52, v53
    v_cvt_pk_bf16_f32 v79, v54, v55
    s_add_u32 s65, s65, 32768
    s_cmp_ge_u32 s65, 98304
    v_mfma_f32_16x16x32_bf16 v[88:91], a[80:83], v[76:79], v[88:91]
    s_cselect_b32 s59, 98304, 0
    s_sub_u32 s65, s65, s59
    v_mfma_f32_16x16x32_bf16 v[100:103], a[84:87], v[76:79], v[100:103]
    s_sub_u32 s67, 32768, s59
    v_add_u32 v8, s67, v8
    v_mfma_f32_16x16x32_bf16 v[112:115], a[88:91], v[76:79], v[112:115]
    v_add_u32 v9, s67, v9
    v_add_u32 v10, s67, v10
    v_mfma_f32_16x16x32_bf16 v[124:127], a[92:95], v[76:79], v[124:127]
    v_add_u32 v11, s67, v11
    v_add_u32 v12, s67, v12
    v_mfma_f32_16x16x32_bf16 v[136:139], a[96:99], v[76:79], v[136:139]
    v_add_u32 v13, s67, v13
    v_add_u32 v14, s67, v14
    v_mfma_f32_16x16x32_bf16 v[148:151], a[100:103], v[76:79], v[148:151]
    v_add_u32 v15, s67, v15
    v_add_u32 v16, s67, v16
    v_mfma_f32_16x16x32_bf16 v[160:163], a[104:107], v[76:79], v[160:163]
    v_add_u32 v17, s67, v17
    v_add_u32 v18, s67, v18
    v_mfma_f32_16x16x32_bf16 v[172:175], a[108:111], v[76:79], v[172:175]
    v_add_u32 v19, s67, v19
    v_mfma_f32_16x16x32_bf16 v[184:187], v[188:191], v[76:79], v[184:187]
    s_mov_b32 s60, 0x8554
    s_bitcmp1_b32 s60, s53
    s_cbranch_scc1 L_hd_26
L_hb_25:
    s_sub_u32 s53, s53, 1
    s_cmp_lg_u32 s53, 0
    s_cbranch_scc1 L_loop_14
    s_waitcnt vmcnt(0)
    s_barrier
    s_add_u32 s74, s48, 0
    s_lshr_b32 s58, s74, 2
    s_add_u32 s58, s58, s85
    s_add_u32 s76, s74, s87
    s_and_b32 s58, s58, 3
    s_lshl_b32 s58, s58, 2
    s_and_b32 s76, s76, 3
    s_add_u32 s58, s58, s76
    s_mul_i32 s58, s58, 6144
    s_add_u32 s58, s58, s73
    s_mul_i32 s75, s48, 6144
    s_add_u32 m0, s75, 57344
    s_nop 0
    buffer_load_dwordx4 v23, s[40:43], s58 offen offset:0 sc1 lds
    s_mul_i32 s57, s48, 12288
    v_add_u32 v30, s57, v23
    ds_write_b128 v30, v[128:131] offset:0
    v_mov_b32 v192, v56
    v_mov_b32 v195, v176
    v_mov_b32 v193, v60
    v_mov_b32 v196, v180
    v_mov_b32 v194, v64
    v_mov_b32 v197, v184
    ds_write_b128 v30, v[132:135] offset:1024
    v_lshrrev_b32 v31, 1, v23
    buffer_load_dwordx4 v23, s[40:43], s58 offen offset:1024 sc1 lds
    ds_write_b128 v30, v[136:139] offset:2048
    ds_write_b128 v30, v[140:143] offset:3072
    buffer_load_dwordx4 v23, s[40:43], s58 offen offset:2048 sc1 lds
    ds_write_b128 v30, v[144:147] offset:4096
    ds_write_b128 v30, v[148:151] offset:5120
    buffer_load_dwordx4 v23, s[40:43], s58 offen offset:3072 sc1 lds
    s_add_u32 m0, s75, 61440
    s_add_u32 s58, s58, 4096
    ds_write_b128 v30, v[152:155] offset:6144
    ds_write_b128 v30, v[156:159] offset:7168
    buffer_load_dwordx4 v23, s[40:43], s58 offen offset:0 sc1 lds
    ds_write_b128 v30, v[160:163] offset:8192
    ds_write_b128 v30, v[164:167] offset:9216
    buffer_load_dwordx4 v23, s[40:43], s58 offen offset:1024 sc1 lds
    ds_write_b128 v30, v[168:171] offset:10240
    s_lshl_b32 s58, s48, 11
    s_add_u32 s58, s58, 49152
    v_add_u32 v31, s58, v31
    s_lshl_b32 s57, s87, 2
    s_add_u32 s57, s57, s85
    s_mul_i32 s57, s57, 196608
    ds_write_b128 v30, v[172:175] offset:11264
    s_lshr_b32 s58, s84, 1
    s_mul_i32 s59, s58, 6144
    s_add_u32 s57, s57, s59
    s_and_b32 s59, s84, 1
    s_mul_i32 s59, s59, 3
    s_add_u32 s59, s59, s48
    ds_write_b64 v31, v[192:193] offset:0
    s_lshl_b32 s60, s59, 10
    s_add_u32 s57, s57, s60
    ds_write_b64 v31, v[194:195] offset:512
    s_add_u32 s89, s57, 17825792
    s_mul_i32 s57, s87, 96
    ds_write_b64 v31, v[196:197] offset:1024
    s_lshl_b32 s59, s59, 4
    s_add_u32 s57, s57, s59
    s_lshl_b32 s57, s57, 10
    s_lshl_b32 s59, s85, 8
    s_add_u32 s57, s57, s59
    s_lshl_b32 s58, s58, 6
    s_add_u32 s90, s57, s58
    s_waitcnt lgkmcnt(0)
    s_barrier
    s_xor_b32 s59, s48, 1
    s_mul_i32 s57, s59, 12288
    v_add_u32 v30, s57, v23
    v_lshrrev_b32 v31, 1, v23
    s_lshl_b32 s58, s59, 11
    s_add_u32 s58, s58, 49152
    v_add_u32 v31, s58, v31
    ds_read_b64 v[200:201], v31 offset:0
    s_lshl_b32 s57, s52, 5
    ds_read_b64 v[202:203], v31 offset:512
    s_add_u32 s57, s57, s51
    ds_read_b64 v[204:205], v31 offset:1024
    s_lshl_b32 s57, s57, 1
    ds_read_b128 v[208:211], v30 offset:0
    s_add_u32 s57, s57, s50
    s_mul_i32 s57, s57, 12288
    s_mul_i32 s58, s49, 3072
    ds_read_b128 v[220:223], v30 offset:3072
    s_add_u32 s57, s57, s58
    s_add_u32 s58, s57, 6144
    s_add_u32 s74, s85, 2
    ds_read_b128 v[232:235], v30 offset:6144
    s_add_u32 s76, s87, 8
    s_and_b32 s74, s74, 3
    s_lshl_b32 s74, s74, 2
    ds_read_b128 v[244:247], v30 offset:9216
    s_and_b32 s76, s76, 3
    s_add_u32 s74, s74, s76
    s_lshl_b32 s74, s74, 15
    ds_read_b128 v[212:215], v30 offset:1024
    s_add_u32 s74, s74, s72
    s_waitcnt lgkmcnt(7)
    v_min_f32 v32, v56, v200
    v_sub_f32 v33, v32, v56
    ds_read_b128 v[224:227], v30 offset:4096
    v_sub_f32 v34, v32, v200
    v_exp_f32 v33, v33
    ds_read_b128 v[236:239], v30 offset:7168
    v_exp_f32 v34, v34
    v_mul_f32 v35, v33, v176
    ds_read_b128 v[248:251], v30 offset:10240
    s_waitcnt lgkmcnt(9)
    v_fmac_f32 v35, v34, v203
    v_rcp_f32 v35, v35
    ds_read_b128 v[216:219], v30 offset:2048
    v_mul_f32 v33, v33, v35
    v_mul_f32 v34, v34, v35
    v_mul_f32 v80, v33, v80
    ds_read_b128 v[228:231], v30 offset:5120
    s_waitcnt lgkmcnt(9)
    v_fmac_f32 v80, v34, v208
    v_mul_f32 v81, v33, v81
    v_fmac_f32 v81, v34, v209
    ds_read_b128 v[240:243], v30 offset:8192
    v_mul_f32 v82, v33, v82
    v_fmac_f32 v82, v34, v210
    v_mul_f32 v83, v33, v83
    ds_read_b128 v[252:255], v30 offset:11264
    v_fmac_f32 v83, v34, v211
    v_mul_f32 v92, v33, v92
    s_waitcnt lgkmcnt(10)
    v_fmac_f32 v92, v34, v220
    v_mul_f32 v93, v33, v93
    v_fmac_f32 v93, v34, v221
    v_mul_f32 v94, v33, v94
    v_fmac_f32 v94, v34, v222
    v_mul_f32 v95, v33, v95
    v_fmac_f32 v95, v34, v223
    v_cvt_pk_bf16_f32 v208, v80, v81
    v_cvt_pk_bf16_f32 v209, v82, v83
    v_cvt_pk_bf16_f32 v210, v92, v93
    v_cvt_pk_bf16_f32 v211, v94, v95
    buffer_store_dwordx4 v[208:211], v23, s[40:43], s57 offen offset:0 sc1
    v_mul_f32 v104, v33, v104
    s_waitcnt lgkmcnt(9)
    v_fmac_f32 v104, v34, v232
    v_mul_f32 v105, v33, v105
    v_fmac_f32 v105, v34, v233
    v_mul_f32 v106, v33, v106
    v_fmac_f32 v106, v34, v234
    v_mul_f32 v107, v33, v107
    v_fmac_f32 v107, v34, v235
    v_mul_f32 v116, v33, v116
    s_waitcnt lgkmcnt(8)
    v_fmac_f32 v116, v34, v244
    v_mul_f32 v117, v33, v117
    v_fmac_f32 v117, v34, v245
    v_mul_f32 v118, v33, v118
    v_fmac_f32 v118, v34, v246
    v_mul_f32 v119, v33, v119
    v_fmac_f32 v119, v34, v247
    v_cvt_pk_bf16_f32 v232, v104, v105
    v_cvt_pk_bf16_f32 v233, v106, v107
    v_cvt_pk_bf16_f32 v234, v116, v117
    v_cvt_pk_bf16_f32 v235, v118, v119
    buffer_store_dwordx4 v[232:235], v23, s[40:43], s58 offen offset:0 sc1
    v_min_f32 v36, v60, v201
    v_sub_f32 v37, v36, v60
    v_sub_f32 v38, v36, v201
    v_exp_f32 v37, v37
    v_exp_f32 v38, v38
    v_mul_f32 v39, v37, v180
    v_fmac_f32 v39, v38, v204
    v_rcp_f32 v39, v39
    v_min_f32 v40, v64, v202
    v_mul_f32 v37, v37, v39
    v_mul_f32 v38, v38, v39
    v_mul_f32 v84, v37, v84
    s_waitcnt lgkmcnt(7)
    v_fmac_f32 v84, v38, v212
    v_mul_f32 v85, v37, v85
    v_fmac_f32 v85, v38, v213
    v_mul_f32 v86, v37, v86
    v_fmac_f32 v86, v38, v214
    v_mul_f32 v87, v37, v87
    v_fmac_f32 v87, v38, v215
    v_mul_f32 v96, v37, v96
    s_waitcnt lgkmcnt(6)
    v_fmac_f32 v96, v38, v224
    v_mul_f32 v97, v37, v97
    v_fmac_f32 v97, v38, v225
    v_mul_f32 v98, v37, v98
    v_fmac_f32 v98, v38, v226
    v_mul_f32 v99, v37, v99
    v_fmac_f32 v99, v38, v227
    v_cvt_pk_bf16_f32 v212, v84, v85
    v_cvt_pk_bf16_f32 v213, v86, v87
    v_cvt_pk_bf16_f32 v214, v96, v97
    v_cvt_pk_bf16_f32 v215, v98, v99
    buffer_store_dwordx4 v[212:215], v23, s[40:43], s57 offen offset:1024 sc1
    v_mul_f32 v108, v37, v108
    s_waitcnt lgkmcnt(5)
    v_fmac_f32 v108, v38, v236
    v_mul_f32 v109, v37, v109
    v_fmac_f32 v109, v38, v237
    v_mul_f32 v110, v37, v110
    v_fmac_f32 v110, v38, v238
    v_mul_f32 v111, v37, v111
    v_fmac_f32 v111, v38, v239
    v_mul_f32 v120, v37, v120
    s_waitcnt lgkmcnt(4)
    v_fmac_f32 v120, v38, v248
    v_mul_f32 v121, v37, v121
    v_fmac_f32 v121, v38, v249
    v_mul_f32 v122, v37, v122
    v_fmac_f32 v122, v38, v250
    v_mul_f32 v123, v37, v123
    v_fmac_f32 v123, v38, v251
    v_cvt_pk_bf16_f32 v236, v108, v109
    v_cvt_pk_bf16_f32 v237, v110, v111
    v_cvt_pk_bf16_f32 v238, v120, v121
    v_cvt_pk_bf16_f32 v239, v122, v123
    buffer_store_dwordx4 v[236:239], v23, s[40:43], s58 offen offset:1024 sc1
    v_sub_f32 v41, v40, v64
    v_sub_f32 v42, v40, v202
    v_exp_f32 v41, v41
    v_exp_f32 v42, v42
    v_mul_f32 v43, v41, v184
    v_fmac_f32 v43, v42, v205
    v_rcp_f32 v43, v43
    s_lshl_b32 s75, s48, 11
    v_mul_f32 v41, v41, v43
    v_mul_f32 v42, v42, v43
    v_mul_f32 v88, v41, v88
    s_waitcnt lgkmcnt(3)
    v_fmac_f32 v88, v42, v216
    v_mul_f32 v89, v41, v89
    v_fmac_f32 v89, v42, v217
    v_mul_f32 v90, v41, v90
    v_fmac_f32 v90, v42, v218
    v_mul_f32 v91, v41, v91
    v_fmac_f32 v91, v42, v219
    v_mul_f32 v100, v41, v100
    s_waitcnt lgkmcnt(2)
    v_fmac_f32 v100, v42, v228
    v_mul_f32 v101, v41, v101
    v_fmac_f32 v101, v42, v229
    v_mul_f32 v102, v41, v102
    v_fmac_f32 v102, v42, v230
    v_mul_f32 v103, v41, v103
    v_fmac_f32 v103, v42, v231
    v_cvt_pk_bf16_f32 v216, v88, v89
    v_cvt_pk_bf16_f32 v217, v90, v91
    v_cvt_pk_bf16_f32 v218, v100, v101
    v_cvt_pk_bf16_f32 v219, v102, v103
    buffer_store_dwordx4 v[216:219], v23, s[40:43], s57 offen offset:2048 sc1
    v_mul_f32 v112, v41, v112
    s_waitcnt lgkmcnt(1)
    v_fmac_f32 v112, v42, v240
    v_mul_f32 v113, v41, v113
    v_fmac_f32 v113, v42, v241
    v_mul_f32 v114, v41, v114
    v_fmac_f32 v114, v42, v242
    v_mul_f32 v115, v41, v115
    v_fmac_f32 v115, v42, v243
    v_mul_f32 v124, v41, v124
    s_waitcnt lgkmcnt(0)
    v_fmac_f32 v124, v42, v252
    v_mul_f32 v125, v41, v125
    v_fmac_f32 v125, v42, v253
    v_mul_f32 v126, v41, v126
    v_fmac_f32 v126, v42, v254
    v_mul_f32 v127, v41, v127
    v_fmac_f32 v127, v42, v255
    v_cvt_pk_bf16_f32 v240, v112, v113
    v_cvt_pk_bf16_f32 v241, v114, v115
    v_cvt_pk_bf16_f32 v242, v124, v125
    v_cvt_pk_bf16_f32 v243, v126, v127
    buffer_store_dwordx4 v[240:243], v23, s[40:43], s58 offen offset:2048 sc1
    s_add_u32 m0, s75, 98304
    s_nop 0
    buffer_load_dwordx4 v20, s[36:39], s74 offen  lds
    s_add_u32 s74, s74, 4096
    s_add_u32 m0, s75, 99328
    s_nop 0
    buffer_load_dwordx4 v21, s[36:39], s74 offen  lds
    s_add_u32 s74, s85, 2
    s_add_u32 s76, s87, 9
    s_and_b32 s74, s74, 3
    s_lshl_b32 s74, s74, 2
    s_and_b32 s76, s76, 3
    s_add_u32 s74, s74, s76
    s_lshl_b32 s74, s74, 15
    s_add_u32 s74, s74, s72
    s_lshl_b32 s75, s48, 11
    s_add_u32 m0, s75, 106496
    s_nop 0
    buffer_load_dwordx4 v20, s[36:39], s74 offen  lds
    s_add_u32 s74, s74, 4096
    s_add_u32 m0, s75, 107520
    s_nop 0
    buffer_load_dwordx4 v21, s[36:39], s74 offen  lds
    s_add_u32 s74, s85, 2
    s_add_u32 s76, s87, 10
    s_and_b32 s74, s74, 3
    s_lshl_b32 s74, s74, 2
    s_and_b32 s76, s76, 3
    s_add_u32 s74, s74, s76
    s_lshl_b32 s74, s74, 15
    s_add_u32 s74, s74, s72
    s_lshl_b32 s75, s48, 11
    s_add_u32 m0, s75, 114688
    s_nop 0
    buffer_load_dwordx4 v20, s[36:39], s74 offen  lds
    s_add_u32 s74, s74, 4096
    s_add_u32 m0, s75, 115712
    s_nop 0
    buffer_load_dwordx4 v21, s[36:39], s74 offen  lds
    s_add_u32 s74, s85, 2
    s_add_u32 s76, s87, 11
    s_and_b32 s74, s74, 3
    s_lshl_b32 s74, s74, 2
    s_and_b32 s76, s76, 3
    s_add_u32 s74, s74, s76
    s_lshl_b32 s74, s74, 15
    s_add_u32 s74, s74, s72
    s_lshl_b32 s75, s48, 11
    s_add_u32 m0, s75, 122880
    s_nop 0
    buffer_load_dwordx4 v20, s[36:39], s74 offen  lds
    s_add_u32 s74, s74, 4096
    s_add_u32 m0, s75, 123904
    s_nop 0
    buffer_load_dwordx4 v21, s[36:39], s74 offen  lds
    s_add_u32 s74, s85, 3
    s_add_u32 s76, s87, 12
    s_and_b32 s74, s74, 3
    s_lshl_b32 s74, s74, 2
    s_and_b32 s76, s76, 3
    s_add_u32 s74, s74, s76
    s_lshl_b32 s74, s74, 15
    s_add_u32 s74, s74, s72
    s_lshl_b32 s75, s48, 11
    s_add_u32 m0, s75, 131072
    s_nop 0
    buffer_load_dwordx4 v20, s[36:39], s74 offen  lds
    s_add_u32 s74, s74, 4096
    s_add_u32 m0, s75, 132096
    s_nop 0
    buffer_load_dwordx4 v21, s[36:39], s74 offen  lds
    s_add_u32 s74, s85, 3
    s_add_u32 s76, s87, 13
    s_and_b32 s74, s74, 3
    s_lshl_b32 s74, s74, 2
    s_and_b32 s76, s76, 3
    s_add_u32 s74, s74, s76
    s_lshl_b32 s74, s74, 15
    s_add_u32 s74, s74, s72
    s_lshl_b32 s75, s48, 11
    s_add_u32 m0, s75, 139264
    s_nop 0
    buffer_load_dwordx4 v20, s[36:39], s74 offen  lds
    s_add_u32 s74, s74, 4096
    s_add_u32 m0, s75, 140288
    s_nop 0
    buffer_load_dwordx4 v21, s[36:39], s74 offen  lds
    s_add_u32 s74, s85, 3
    s_add_u32 s76, s87, 14
    s_and_b32 s74, s74, 3
    s_lshl_b32 s74, s74, 2
    s_and_b32 s76, s76, 3
    s_add_u32 s74, s74, s76
    s_lshl_b32 s74, s74, 15
    s_add_u32 s74, s74, s72
    s_lshl_b32 s75, s48, 11
    s_add_u32 m0, s75, 147456
    s_nop 0
    buffer_load_dwordx4 v20, s[36:39], s74 offen  lds
    s_add_u32 s74, s74, 4096
    s_add_u32 m0, s75, 148480
    s_nop 0
    buffer_load_dwordx4 v21, s[36:39], s74 offen  lds
    s_add_u32 s74, s85, 3
    s_add_u32 s76, s87, 15
    s_and_b32 s74, s74, 3
    s_lshl_b32 s74, s74, 2
    s_and_b32 s76, s76, 3
    s_add_u32 s74, s74, s76
    s_lshl_b32 s74, s74, 15
    s_add_u32 s74, s74, s72
    s_lshl_b32 s75, s48, 11
    s_add_u32 m0, s75, 155648
    s_nop 0
    buffer_load_dwordx4 v20, s[36:39], s74 offen  lds
    s_add_u32 s74, s74, 4096
    s_add_u32 m0, s75, 156672
    s_nop 0
    buffer_load_dwordx4 v21, s[36:39], s74 offen  lds
    s_waitcnt lgkmcnt(0)
    s_waitcnt vmcnt(16)
    s_barrier
    s_cmp_lg_u32 s48, 3
    s_cbranch_scc1 L_w0_27
    v_mov_b32 v204, 1
    v_mov_b32 v205, 0
    s_mov_b64 exec, 1
    s_lshl_b32 s59, s85, 2
    s_add_u32 s59, s59, s62
    s_add_u32 s59, s59, 8192
    buffer_store_dword v204, v205, s[40:43], s59 offen sc1
    s_mov_b64 exec, -1
L_w0_27:
    v_add_u32 v192, 0x10000, v23
    v_add_u32 v193, 0x20000, v23
    s_add_u32 s74, s48, 4
    s_lshr_b32 s58, s74, 2
    s_add_u32 s58, s58, s85
    s_add_u32 s76, s74, s87
    s_and_b32 s58, s58, 3
    s_lshl_b32 s58, s58, 2
    s_and_b32 s76, s76, 3
    s_add_u32 s58, s58, s76
    s_mul_i32 s58, s58, 6144
    s_add_u32 s58, s58, s73
    s_mul_i32 s75, s48, 6144
    s_add_u32 m0, s75, 0
    s_nop 0
    buffer_load_dwordx4 v23, s[40:43], s58 offen offset:0 sc1 lds
    ds_read_b128 a[0:3], v23 offset:57344
    ds_read_b128 a[4:7], v23 offset:58368
    ds_read_b128 a[8:11], v23 offset:59392
    ds_read_b128 a[12:15], v23 offset:60416
    buffer_load_dwordx4 v23, s[40:43], s58 offen offset:1024 sc1 lds
    ds_read_b128 a[16:19], v23 offset:61440
    ds_read_b128 a[20:23], v23 offset:62464
    ds_read_b128 a[24:27], v23 offset:63488
    s_waitcnt lgkmcnt(6)
    v_mfma_f32_16x16x32_bf16 v[80:83], a[112:115], a[0:3], 0
    ds_read_b128 a[28:31], v23 offset:64512
    v_mfma_f32_16x16x32_bf16 v[104:107], a[116:119], a[0:3], 0
    buffer_load_dwordx4 v23, s[40:43], s58 offen offset:2048 sc1 lds
    s_waitcnt lgkmcnt(6)
    v_mfma_f32_16x16x32_bf16 v[84:87], a[112:115], a[4:7], 0
    ds_read_b128 a[32:35], v192 offset:0
    v_mfma_f32_16x16x32_bf16 v[108:111], a[116:119], a[4:7], 0
    ds_read_b128 a[36:39], v192 offset:1024
    s_waitcnt lgkmcnt(7)
    v_mfma_f32_16x16x32_bf16 v[88:91], a[112:115], a[8:11], 0
    ds_read_b128 a[40:43], v192 offset:2048
    v_mfma_f32_16x16x32_bf16 v[112:115], a[116:119], a[8:11], 0
    buffer_load_dwordx4 v23, s[40:43], s58 offen offset:3072 sc1 lds
    s_waitcnt lgkmcnt(7)
    v_mfma_f32_16x16x32_bf16 v[92:95], a[112:115], a[12:15], 0
    s_add_u32 m0, s75, 4096
    s_add_u32 s58, s58, 4096
    v_mfma_f32_16x16x32_bf16 v[116:119], a[116:119], a[12:15], 0
    s_add_u32 s74, s48, 8
    s_mul_i32 s75, s48, 6144
    s_waitcnt lgkmcnt(6)
    v_mfma_f32_16x16x32_bf16 v[96:99], a[112:115], a[16:19], 0
    ds_read_b128 a[44:47], v192 offset:3072
    v_mfma_f32_16x16x32_bf16 v[120:123], a[116:119], a[16:19], 0
    buffer_load_dwordx4 v23, s[40:43], s58 offen offset:0 sc1 lds
    s_waitcnt lgkmcnt(6)
    v_mfma_f32_16x16x32_bf16 v[100:103], a[112:115], a[20:23], 0
    ds_read_b128 a[48:51], v192 offset:4096
    v_mfma_f32_16x16x32_bf16 v[124:127], a[116:119], a[20:23], 0
    ds_read_b128 a[52:55], v192 offset:5120
    s_waitcnt lgkmcnt(7)
    v_mfma_f32_16x16x32_bf16 v[80:83], a[120:123], a[24:27], v[80:83]
    ds_read_b128 a[56:59], v192 offset:6144
    v_mfma_f32_16x16x32_bf16 v[104:107], a[124:127], a[24:27], v[104:107]
    buffer_load_dwordx4 v23, s[40:43], s58 offen offset:1024 sc1 lds
    s_waitcnt lgkmcnt(7)
    v_mfma_f32_16x16x32_bf16 v[84:87], a[120:123], a[28:31], v[84:87]
    s_lshr_b32 s58, s74, 2
    s_add_u32 s58, s58, s85
    v_mfma_f32_16x16x32_bf16 v[108:111], a[124:127], a[28:31], v[108:111]
    s_add_u32 s76, s74, s87
    s_and_b32 s58, s58, 3
    s_waitcnt lgkmcnt(6)
    v_mfma_f32_16x16x32_bf16 v[88:91], a[120:123], a[32:35], v[88:91]
    s_lshl_b32 s58, s58, 2
    s_and_b32 s76, s76, 3
    v_mfma_f32_16x16x32_bf16 v[112:115], a[124:127], a[32:35], v[112:115]
    s_add_u32 s58, s58, s76
    s_mul_i32 s58, s58, 6144
    s_waitcnt lgkmcnt(5)
    v_mfma_f32_16x16x32_bf16 v[92:95], a[120:123], a[36:39], v[92:95]
    s_add_u32 s58, s58, s73
    s_add_u32 m0, s75, 24576
    v_mfma_f32_16x16x32_bf16 v[116:119], a[124:127], a[36:39], v[116:119]
    buffer_load_dwordx4 v23, s[40:43], s58 offen offset:0 sc1 lds
    s_waitcnt lgkmcnt(4)
    v_mfma_f32_16x16x32_bf16 v[96:99], a[120:123], a[40:43], v[96:99]
    ds_read_b128 a[60:63], v192 offset:7168
    v_mfma_f32_16x16x32_bf16 v[120:123], a[124:127], a[40:43], v[120:123]
    ds_read_b128 a[64:67], v192 offset:8192
    s_waitcnt lgkmcnt(5)
    v_mfma_f32_16x16x32_bf16 v[100:103], a[120:123], a[44:47], v[100:103]
    ds_read_b128 a[68:71], v192 offset:9216
    v_mfma_f32_16x16x32_bf16 v[124:127], a[124:127], a[44:47], v[124:127]
    buffer_load_dwordx4 v23, s[40:43], s58 offen offset:1024 sc1 lds
    s_waitcnt lgkmcnt(5)
    v_mfma_f32_16x16x32_bf16 v[80:83], a[128:131], a[48:51], v[80:83]
    ds_read_b128 a[72:75], v192 offset:10240
    v_mfma_f32_16x16x32_bf16 v[104:107], a[132:135], a[48:51], v[104:107]
    ds_read_b128 a[76:79], v192 offset:11264
    s_waitcnt lgkmcnt(6)
    v_mfma_f32_16x16x32_bf16 v[84:87], a[128:131], a[52:55], v[84:87]
    ds_read_b128 a[80:83], v192 offset:12288
    v_mfma_f32_16x16x32_bf16 v[108:111], a[132:135], a[52:55], v[108:111]
    buffer_load_dwordx4 v23, s[40:43], s58 offen offset:2048 sc1 lds
    s_waitcnt lgkmcnt(6)
    v_mfma_f32_16x16x32_bf16 v[88:91], a[128:131], a[56:59], v[88:91]
    ds_read_b128 a[84:87], v192 offset:13312
    v_mfma_f32_16x16x32_bf16 v[112:115], a[132:135], a[56:59], v[112:115]
    ds_read_b128 a[88:91], v192 offset:14336
    s_waitcnt lgkmcnt(7)
    v_mfma_f32_16x16x32_bf16 v[92:95], a[128:131], a[60:63], v[92:95]
    ds_read_b128 a[92:95], v192 offset:15360
    v_mfma_f32_16x16x32_bf16 v[116:119], a[132:135], a[60:63], v[116:119]
    buffer_load_dwordx4 v23, s[40:43], s58 offen offset:3072 sc1 lds
    s_waitcnt lgkmcnt(7)
    v_mfma_f32_16x16x32_bf16 v[96:99], a[128:131], a[64:67], v[96:99]
    s_add_u32 m0, s75, 28672
    s_add_u32 s58, s58, 4096
    v_mfma_f32_16x16x32_bf16 v[120:123], a[132:135], a[64:67], v[120:123]
    s_waitcnt lgkmcnt(6)
    v_mfma_f32_16x16x32_bf16 v[100:103], a[128:131], a[68:71], v[100:103]
    v_mfma_f32_16x16x32_bf16 v[124:127], a[132:135], a[68:71], v[124:127]
    buffer_load_dwordx4 v23, s[40:43], s58 offen offset:0 sc1 lds
    s_waitcnt lgkmcnt(5)
    v_mfma_f32_16x16x32_bf16 v[80:83], a[136:139], a[72:75], v[80:83]
    v_mfma_f32_16x16x32_bf16 v[104:107], a[140:143], a[72:75], v[104:107]
    s_waitcnt lgkmcnt(4)
    v_mfma_f32_16x16x32_bf16 v[84:87], a[136:139], a[76:79], v[84:87]
    v_mfma_f32_16x16x32_bf16 v[108:111], a[140:143], a[76:79], v[108:111]
    buffer_load_dwordx4 v23, s[40:43], s58 offen offset:1024 sc1 lds
    s_waitcnt lgkmcnt(3)
    v_mfma_f32_16x16x32_bf16 v[88:91], a[136:139], a[80:83], v[88:91]
    v_mfma_f32_16x16x32_bf16 v[112:115], a[140:143], a[80:83], v[112:115]
    s_waitcnt lgkmcnt(2)
    v_mfma_f32_16x16x32_bf16 v[92:95], a[136:139], a[84:87], v[92:95]
    v_mfma_f32_16x16x32_bf16 v[116:119], a[140:143], a[84:87], v[116:119]
    s_waitcnt lgkmcnt(1)
    v_mfma_f32_16x16x32_bf16 v[96:99], a[136:139], a[88:91], v[96:99]
    v_mfma_f32_16x16x32_bf16 v[120:123], a[140:143], a[88:91], v[120:123]
    s_waitcnt lgkmcnt(0)
    v_mfma_f32_16x16x32_bf16 v[100:103], a[136:139], a[92:95], v[100:103]
    v_mfma_f32_16x16x32_bf16 v[124:127], a[140:143], a[92:95], v[124:127]
    s_waitcnt vmcnt(6)
    s_waitcnt lgkmcnt(0)
    s_barrier
    s_cmp_lg_u32 s48, 3
    s_cbranch_scc1 L_w0_28
    v_and_b32 v205, 3, v0
    v_lshlrev_b32 v205, 2, v205
    s_add_u32 s59, s62, 8192
    buffer_load_dword v207, v205, s[40:43], s59 offen sc1
L_w0_28:
    v_add_u32 v192, 0x10000, v23
    v_add_u32 v193, 0x20000, v23
    v_add_u32 v198, 98304, v24
    v_add_u32 v199, 98304, v25
    ds_read_b64_tr_b16 a[176:177], v198 offset:0
    s_add_u32 s74, s48, 12
    ds_read_b64_tr_b16 a[178:179], v198 offset:4096
    s_lshr_b32 s58, s74, 2
    ds_read_b64_tr_b16 a[180:181], v199 offset:0
    s_add_u32 s58, s58, s85
    ds_read_b64_tr_b16 a[182:183], v199 offset:4096
    s_add_u32 s76, s74, s87
    ds_read_b64_tr_b16 a[184:185], v198 offset:8192
    s_and_b32 s58, s58, 3
    ds_read_b64_tr_b16 a[186:187], v198 offset:12288
    s_lshl_b32 s58, s58, 2
    ds_read_b64_tr_b16 a[188:189], v199 offset:8192
    s_and_b32 s76, s76, 3
    ds_read_b64_tr_b16 a[190:191], v199 offset:12288
    s_add_u32 s58, s58, s76
    ds_read_b64_tr_b16 a[192:193], v198 offset:16384
    s_mul_i32 s58, s58, 6144
    ds_read_b64_tr_b16 a[194:195], v198 offset:20480
    s_add_u32 s58, s58, s73
    ds_read_b64_tr_b16 a[196:197], v199 offset:16384
    s_mul_i32 s75, s48, 6144
    ds_read_b64_tr_b16 a[198:199], v199 offset:20480
    s_add_u32 m0, s75, 57344
    ds_read_b64_tr_b16 a[200:201], v198 offset:24576
    buffer_load_dwordx4 v23, s[40:43], s58 offen offset:0 sc1 lds
    ds_read_b64_tr_b16 a[202:203], v198 offset:28672
    ds_read_b128 a[0:3], v23 offset:0
    ds_read_b128 a[4:7], v23 offset:1024
    ds_read_b128 a[8:11], v23 offset:2048
    ds_read_b128 a[12:15], v23 offset:3072
    buffer_load_dwordx4 v23, s[40:43], s58 offen offset:1024 sc1 lds
    ds_read_b128 a[16:19], v23 offset:4096
    ds_read_b128 a[20:23], v23 offset:5120
    ds_read_b128 a[24:27], v23 offset:6144
    s_waitcnt lgkmcnt(6)
    v_mfma_f32_16x16x32_bf16 v[80:83], a[144:147], a[0:3], v[80:83]
    ds_read_b128 a[28:31], v23 offset:7168
    v_mfma_f32_16x16x32_bf16 v[104:107], a[148:151], a[0:3], v[104:107]
    buffer_load_dwordx4 v23, s[40:43], s58 offen offset:2048 sc1 lds
    s_waitcnt lgkmcnt(6)
    v_mfma_f32_16x16x32_bf16 v[84:87], a[144:147], a[4:7], v[84:87]
    ds_read_b64_tr_b16 a[204:205], v199 offset:24576
    ds_read_b128 a[32:35], v23 offset:8192
    v_mfma_f32_16x16x32_bf16 v[108:111], a[148:151], a[4:7], v[108:111]
    ds_read_b128 a[36:39], v23 offset:9216
    s_waitcnt lgkmcnt(8)
    v_mfma_f32_16x16x32_bf16 v[88:91], a[144:147], a[8:11], v[88:91]
    ds_read_b128 a[40:43], v23 offset:10240
    v_mfma_f32_16x16x32_bf16 v[112:115], a[148:151], a[8:11], v[112:115]
    buffer_load_dwordx4 v23, s[40:43], s58 offen offset:3072 sc1 lds
    s_waitcnt lgkmcnt(8)
    v_mfma_f32_16x16x32_bf16 v[92:95], a[144:147], a[12:15], v[92:95]
    ds_read_b64_tr_b16 a[206:207], v199 offset:28672
    s_add_u32 m0, s75, 61440
    v_mfma_f32_16x16x32_bf16 v[116:119], a[148:151], a[12:15], v[116:119]
    ds_read_b64_tr_b16 a[208:209], v198 offset:32768
    s_add_u32 s58, s58, 4096
    s_waitcnt lgkmcnt(9)
    v_mfma_f32_16x16x32_bf16 v[96:99], a[144:147], a[16:19], v[96:99]
    ds_read_b64_tr_b16 a[210:211], v198 offset:36864
    ds_read_b128 a[44:47], v23 offset:11264
    v_mfma_f32_16x16x32_bf16 v[120:123], a[148:151], a[16:19], v[120:123]
    buffer_load_dwordx4 v23, s[40:43], s58 offen offset:0 sc1 lds
    s_waitcnt lgkmcnt(10)
    v_mfma_f32_16x16x32_bf16 v[100:103], a[144:147], a[20:23], v[100:103]
    ds_read_b64_tr_b16 a[212:213], v199 offset:32768
    ds_read_b128 a[48:51], v23 offset:12288
    v_mfma_f32_16x16x32_bf16 v[124:127], a[148:151], a[20:23], v[124:127]
    ds_read_b128 a[52:55], v23 offset:13312
    s_waitcnt lgkmcnt(12)
    v_mfma_f32_16x16x32_bf16 v[80:83], a[152:155], a[24:27], v[80:83]
    ds_read_b128 a[56:59], v23 offset:14336
    v_mfma_f32_16x16x32_bf16 v[104:107], a[156:159], a[24:27], v[104:107]
    buffer_load_dwordx4 v23, s[40:43], s58 offen offset:1024 sc1 lds
    s_waitcnt lgkmcnt(12)
    v_mfma_f32_16x16x32_bf16 v[84:87], a[152:155], a[28:31], v[84:87]
    ds_read_b64_tr_b16 a[214:215], v199 offset:36864
    ds_read_b128 a[60:63], v23 offset:15360
    v_mfma_f32_16x16x32_bf16 v[108:111], a[156:159], a[28:31], v[108:111]
    ds_read_b128 a[64:67], v23 offset:16384
    s_waitcnt lgkmcnt(13)
    v_mfma_f32_16x16x32_bf16 v[88:91], a[152:155], a[32:35], v[88:91]
    ds_read_b128 a[68:71], v23 offset:17408
    v_mfma_f32_16x16x32_bf16 v[112:115], a[156:159], a[32:35], v[112:115]
    ds_read_b128 a[72:75], v23 offset:18432
    s_waitcnt lgkmcnt(14)
    v_mfma_f32_16x16x32_bf16 v[92:95], a[152:155], a[36:39], v[92:95]
    ds_read_b128 a[76:79], v23 offset:19456
    v_mfma_f32_16x16x32_bf16 v[116:119], a[156:159], a[36:39], v[116:119]
    ds_read_b128 a[80:83], v23 offset:20480
    s_waitcnt lgkmcnt(15)
    v_mfma_f32_16x16x32_bf16 v[96:99], a[152:155], a[40:43], v[96:99]
    ds_read_b128 a[84:87], v23 offset:21504
    v_mfma_f32_16x16x32_bf16 v[120:123], a[156:159], a[40:43], v[120:123]
    ds_read_b128 a[88:91], v23 offset:22528
    s_waitcnt lgkmcnt(13)
    v_mfma_f32_16x16x32_bf16 v[100:103], a[152:155], a[44:47], v[100:103]
    ds_read_b128 a[92:95], v23 offset:23552
    v_mfma_f32_16x16x32_bf16 v[124:127], a[156:159], a[44:47], v[124:127]
    ds_read_b64_tr_b16 a[216:217], v198 offset:40960
    s_waitcnt lgkmcnt(13)
    v_mfma_f32_16x16x32_bf16 v[80:83], a[160:163], a[48:51], v[80:83]
    ds_read_b64_tr_b16 a[218:219], v198 offset:45056
    v_mfma_f32_16x16x32_bf16 v[104:107], a[164:167], a[48:51], v[104:107]
    ds_read_b64_tr_b16 a[220:221], v199 offset:40960
    s_waitcnt lgkmcnt(14)
    v_mfma_f32_16x16x32_bf16 v[84:87], a[160:163], a[52:55], v[84:87]
    ds_read_b64_tr_b16 a[222:223], v199 offset:45056
    v_mfma_f32_16x16x32_bf16 v[108:111], a[164:167], a[52:55], v[108:111]
    ds_read_b64_tr_b16 a[224:225], v198 offset:49152
    s_waitcnt lgkmcnt(15)
    v_mfma_f32_16x16x32_bf16 v[88:91], a[160:163], a[56:59], v[88:91]
    ds_read_b64_tr_b16 a[226:227], v198 offset:53248
    v_mfma_f32_16x16x32_bf16 v[112:115], a[164:167], a[56:59], v[112:115]
    ds_read_b64_tr_b16 a[228:229], v199 offset:49152
    s_waitcnt lgkmcnt(15)
    v_mfma_f32_16x16x32_bf16 v[92:95], a[160:163], a[60:63], v[92:95]
    ds_read_b64_tr_b16 a[230:231], v199 offset:53248
    v_mfma_f32_16x16x32_bf16 v[116:119], a[164:167], a[60:63], v[116:119]
    ds_read_b64_tr_b16 a[232:233], v198 offset:57344
    s_waitcnt lgkmcnt(15)
    v_mfma_f32_16x16x32_bf16 v[96:99], a[160:163], a[64:67], v[96:99]
    ds_read_b64_tr_b16 a[234:235], v198 offset:61440
    v_mfma_f32_16x16x32_bf16 v[120:123], a[164:167], a[64:67], v[120:123]
    ds_read_b64_tr_b16 a[236:237], v199 offset:57344
    v_mfma_f32_16x16x32_bf16 v[100:103], a[160:163], a[68:71], v[100:103]
    ds_read_b64_tr_b16 a[238:239], v199 offset:61440
    v_mfma_f32_16x16x32_bf16 v[124:127], a[164:167], a[68:71], v[124:127]
    s_waitcnt lgkmcnt(15)
    v_mfma_f32_16x16x32_bf16 v[80:83], a[168:171], a[72:75], v[80:83]
    v_mfma_f32_16x16x32_bf16 v[104:107], a[172:175], a[72:75], v[104:107]
    v_mfma_f32_16x16x32_bf16 v[84:87], a[168:171], a[76:79], v[84:87]
    v_mfma_f32_16x16x32_bf16 v[108:111], a[172:175], a[76:79], v[108:111]
    v_mfma_f32_16x16x32_bf16 v[88:91], a[168:171], a[80:83], v[88:91]
    v_mfma_f32_16x16x32_bf16 v[112:115], a[172:175], a[80:83], v[112:115]
    s_waitcnt lgkmcnt(14)
    v_mfma_f32_16x16x32_bf16 v[92:95], a[168:171], a[84:87], v[92:95]
    v_mfma_f32_16x16x32_bf16 v[116:119], a[172:175], a[84:87], v[116:119]
    s_waitcnt lgkmcnt(13)
    v_mfma_f32_16x16x32_bf16 v[96:99], a[168:171], a[88:91], v[96:99]
    v_mfma_f32_16x16x32_bf16 v[120:123], a[172:175], a[88:91], v[120:123]
    s_waitcnt lgkmcnt(12)
    v_mfma_f32_16x16x32_bf16 v[100:103], a[168:171], a[92:95], v[100:103]
    v_mfma_f32_16x16x32_bf16 v[124:127], a[172:175], a[92:95], v[124:127]
    s_waitcnt vmcnt(6)
    s_cmp_lg_u32 s48, 3
    s_cbranch_scc1 L_w0_29
    v_cmp_ne_u32 vcc, 1, v207
    s_nop 3
    s_cbranch_vccz L_pd_31
    s_mov_b32 s60, 0x200000
L_p_30:
    v_and_b32 v205, 3, v0
    v_lshlrev_b32 v205, 2, v205
    s_add_u32 s59, s62, 8192
    buffer_load_dword v204, v205, s[40:43], s59 offen sc1
    s_waitcnt vmcnt(0)
    v_cmp_ne_u32 vcc, 1, v204
    s_nop 3
    s_cbranch_vccz L_done_32
    s_sub_u32 s60, s60, 1
    s_cbranch_scc0 L_p_30
L_done_32:
L_pd_31:
L_w0_29:
    s_waitcnt lgkmcnt(0)
    s_barrier
    v_add_u32 v192, 0x10000, v23
    v_add_u32 v193, 0x20000, v23
    s_add_u32 s74, s48, 0
    s_lshr_b32 s58, s74, 2
    s_add_u32 s58, s58, s85
    s_add_u32 s76, s74, s87
    s_and_b32 s58, s58, 3
    s_lshl_b32 s58, s58, 2
    s_and_b32 s76, s76, 3
    s_add_u32 s58, s58, s76
    s_mul_i32 s58, s58, 6144
    s_add_u32 s58, s58, s73
    s_add_u32 s58, s58, 6291456
    s_mul_i32 s75, s48, 6144
    s_add_u32 m0, s75, 98304
    s_nop 0
    buffer_load_dwordx4 v23, s[40:43], s58 offen offset:0 sc1 lds
    ds_read_b128 a[0:3], v23 offset:24576
    ds_read_b128 a[4:7], v23 offset:25600
    ds_read_b128 a[8:11], v23 offset:26624
    ds_read_b128 a[12:15], v23 offset:27648
    buffer_load_dwordx4 v23, s[40:43], s58 offen offset:1024 sc1 lds
    ds_read_b128 a[16:19], v23 offset:28672
    ds_read_b128 a[20:23], v23 offset:29696
    ds_read_b128 a[24:27], v23 offset:30720
    s_waitcnt lgkmcnt(6)
    v_mfma_f32_16x16x32_bf16 v[80:83], a[176:179], a[0:3], v[80:83]
    ds_read_b128 a[28:31], v23 offset:31744
    v_mfma_f32_16x16x32_bf16 v[104:107], a[180:183], a[0:3], v[104:107]
    buffer_load_dwordx4 v23, s[40:43], s58 offen offset:2048 sc1 lds
    s_waitcnt lgkmcnt(6)
    v_mfma_f32_16x16x32_bf16 v[84:87], a[176:179], a[4:7], v[84:87]
    ds_read_b128 a[32:35], v23 offset:32768
    v_mfma_f32_16x16x32_bf16 v[108:111], a[180:183], a[4:7], v[108:111]
    ds_read_b128 a[36:39], v23 offset:33792
    s_waitcnt lgkmcnt(7)
    v_mfma_f32_16x16x32_bf16 v[88:91], a[176:179], a[8:11], v[88:91]
    ds_read_b128 a[40:43], v23 offset:34816
    v_mfma_f32_16x16x32_bf16 v[112:115], a[180:183], a[8:11], v[112:115]
    buffer_load_dwordx4 v23, s[40:43], s58 offen offset:3072 sc1 lds
    s_waitcnt lgkmcnt(7)
    v_mfma_f32_16x16x32_bf16 v[92:95], a[176:179], a[12:15], v[92:95]
    s_add_u32 m0, s75, 102400
    s_add_u32 s58, s58, 4096
    v_mfma_f32_16x16x32_bf16 v[116:119], a[180:183], a[12:15], v[116:119]
    s_add_u32 s74, s48, 4
    s_mul_i32 s75, s48, 6144
    s_waitcnt lgkmcnt(6)
    v_mfma_f32_16x16x32_bf16 v[96:99], a[176:179], a[16:19], v[96:99]
    ds_read_b128 a[44:47], v23 offset:35840
    v_mfma_f32_16x16x32_bf16 v[120:123], a[180:183], a[16:19], v[120:123]
    buffer_load_dwordx4 v23, s[40:43], s58 offen offset:0 sc1 lds
    s_waitcnt lgkmcnt(6)
    v_mfma_f32_16x16x32_bf16 v[100:103], a[176:179], a[20:23], v[100:103]
    ds_read_b128 a[48:51], v23 offset:36864
    v_mfma_f32_16x16x32_bf16 v[124:127], a[180:183], a[20:23], v[124:127]
    ds_read_b128 a[52:55], v23 offset:37888
    s_waitcnt lgkmcnt(7)
    v_mfma_f32_16x16x32_bf16 v[80:83], a[184:187], a[24:27], v[80:83]
    ds_read_b128 a[56:59], v23 offset:38912
    v_mfma_f32_16x16x32_bf16 v[104:107], a[188:191], a[24:27], v[104:107]
    buffer_load_dwordx4 v23, s[40:43], s58 offen offset:1024 sc1 lds
    s_waitcnt lgkmcnt(7)
    v_mfma_f32_16x16x32_bf16 v[84:87], a[184:187], a[28:31], v[84:87]
    s_lshr_b32 s58, s74, 2
    s_add_u32 s58, s58, s85
    v_mfma_f32_16x16x32_bf16 v[108:111], a[188:191], a[28:31], v[108:111]
    s_add_u32 s76, s74, s87
    s_and_b32 s58, s58, 3
    s_waitcnt lgkmcnt(6)
    v_mfma_f32_16x16x32_bf16 v[88:91], a[184:187], a[32:35], v[88:91]
    s_lshl_b32 s58, s58, 2
    s_and_b32 s76, s76, 3
    v_mfma_f32_16x16x32_bf16 v[112:115], a[188:191], a[32:35], v[112:115]
    s_add_u32 s58, s58, s76
    s_mul_i32 s58, s58, 6144
    s_waitcnt lgkmcnt(5)
    v_mfma_f32_16x16x32_bf16 v[92:95], a[184:187], a[36:39], v[92:95]
    s_add_u32 s58, s58, s73
    s_add_u32 s58, s58, 6291456
    v_mfma_f32_16x16x32_bf16 v[116:119], a[188:191], a[36:39], v[116:119]
    s_add_u32 m0, s75, 122880
    s_nop 0
    buffer_load_dwordx4 v23, s[40:43], s58 offen offset:0 sc1 lds
    s_waitcnt lgkmcnt(4)
    v_mfma_f32_16x16x32_bf16 v[96:99], a[184:187], a[40:43], v[96:99]
    ds_read_b128 a[60:63], v23 offset:39936
    v_mfma_f32_16x16x32_bf16 v[120:123], a[188:191], a[40:43], v[120:123]
    ds_read_b128 a[64:67], v23 offset:40960
    s_waitcnt lgkmcnt(5)
    v_mfma_f32_16x16x32_bf16 v[100:103], a[184:187], a[44:47], v[100:103]
    ds_read_b128 a[68:71], v23 offset:41984
    v_mfma_f32_16x16x32_bf16 v[124:127], a[188:191], a[44:47], v[124:127]
    buffer_load_dwordx4 v23, s[40:43], s58 offen offset:1024 sc1 lds
    s_waitcnt lgkmcnt(5)
    v_mfma_f32_16x16x32_bf16 v[80:83], a[192:195], a[48:51], v[80:83]
    ds_read_b128 a[72:75], v23 offset:43008
    v_mfma_f32_16x16x32_bf16 v[104:107], a[196:199], a[48:51], v[104:107]
    ds_read_b128 a[76:79], v23 offset:44032
    s_waitcnt lgkmcnt(6)
    v_mfma_f32_16x16x32_bf16 v[84:87], a[192:195], a[52:55], v[84:87]
    ds_read_b128 a[80:83], v23 offset:45056
    v_mfma_f32_16x16x32_bf16 v[108:111], a[196:199], a[52:55], v[108:111]
    buffer_load_dwordx4 v23, s[40:43], s58 offen offset:2048 sc1 lds
    s_waitcnt lgkmcnt(6)
    v_mfma_f32_16x16x32_bf16 v[88:91], a[192:195], a[56:59], v[88:91]
    ds_read_b128 a[84:87], v23 offset:46080
    v_mfma_f32_16x16x32_bf16 v[112:115], a[196:199], a[56:59], v[112:115]
    ds_read_b128 a[88:91], v23 offset:47104
    s_waitcnt lgkmcnt(7)
    v_mfma_f32_16x16x32_bf16 v[92:95], a[192:195], a[60:63], v[92:95]
    ds_read_b128 a[92:95], v23 offset:48128
    v_mfma_f32_16x16x32_bf16 v[116:119], a[196:199], a[60:63], v[116:119]
    buffer_load_dwordx4 v23, s[40:43], s58 offen offset:3072 sc1 lds
    s_waitcnt lgkmcnt(7)
    v_mfma_f32_16x16x32_bf16 v[96:99], a[192:195], a[64:67], v[96:99]
    s_add_u32 m0, s75, 126976
    s_add_u32 s58, s58, 4096
    v_mfma_f32_16x16x32_bf16 v[120:123], a[196:199], a[64:67], v[120:123]
    s_waitcnt lgkmcnt(6)
    v_mfma_f32_16x16x32_bf16 v[100:103], a[192:195], a[68:71], v[100:103]
    v_mfma_f32_16x16x32_bf16 v[124:127], a[196:199], a[68:71], v[124:127]
    buffer_load_dwordx4 v23, s[40:43], s58 offen offset:0 sc1 lds
    s_waitcnt lgkmcnt(5)
    v_mfma_f32_16x16x32_bf16 v[80:83], a[200:203], a[72:75], v[80:83]
    v_mfma_f32_16x16x32_bf16 v[104:107], a[204:207], a[72:75], v[104:107]
    s_waitcnt lgkmcnt(4)
    v_mfma_f32_16x16x32_bf16 v[84:87], a[200:203], a[76:79], v[84:87]
    v_mfma_f32_16x16x32_bf16 v[108:111], a[204:207], a[76:79], v[108:111]
    buffer_load_dwordx4 v23, s[40:43], s58 offen offset:1024 sc1 lds
    s_waitcnt lgkmcnt(3)
    v_mfma_f32_16x16x32_bf16 v[88:91], a[200:203], a[80:83], v[88:91]
    v_mfma_f32_16x16x32_bf16 v[112:115], a[204:207], a[80:83], v[112:115]
    s_waitcnt lgkmcnt(2)
    v_mfma_f32_16x16x32_bf16 v[92:95], a[200:203], a[84:87], v[92:95]
    v_mfma_f32_16x16x32_bf16 v[116:119], a[204:207], a[84:87], v[116:119]
    s_waitcnt lgkmcnt(1)
    v_mfma_f32_16x16x32_bf16 v[96:99], a[200:203], a[88:91], v[96:99]
    v_mfma_f32_16x16x32_bf16 v[120:123], a[204:207], a[88:91], v[120:123]
    s_waitcnt lgkmcnt(0)
    v_mfma_f32_16x16x32_bf16 v[100:103], a[200:203], a[92:95], v[100:103]
    v_mfma_f32_16x16x32_bf16 v[124:127], a[204:207], a[92:95], v[124:127]
    s_waitcnt vmcnt(12)
    s_waitcnt lgkmcnt(0)
    s_barrier
    v_add_u32 v192, 0x10000, v23
    v_add_u32 v193, 0x20000, v23
    s_add_u32 s74, s48, 8
    s_lshr_b32 s58, s74, 2
    s_add_u32 s58, s58, s85
    s_add_u32 s76, s74, s87
    s_and_b32 s58, s58, 3
    s_lshl_b32 s58, s58, 2
    s_and_b32 s76, s76, 3
    s_add_u32 s58, s58, s76
    s_mul_i32 s58, s58, 6144
    s_add_u32 s58, s58, s73
    s_add_u32 s58, s58, 6291456
    s_mul_i32 s75, s48, 6144
    s_add_u32 m0, s75, 0
    s_nop 0
    buffer_load_dwordx4 v23, s[40:43], s58 offen offset:0 sc1 lds
    ds_read_b128 a[0:3], v23 offset:57344
    ds_read_b128 a[4:7], v23 offset:58368
    ds_read_b128 a[8:11], v23 offset:59392
    ds_read_b128 a[12:15], v23 offset:60416
    buffer_load_dwordx4 v23, s[40:43], s58 offen offset:1024 sc1 lds
    ds_read_b128 a[16:19], v23 offset:61440
    ds_read_b128 a[20:23], v23 offset:62464
    ds_read_b128 a[24:27], v23 offset:63488
    s_waitcnt lgkmcnt(6)
    v_mfma_f32_16x16x32_bf16 v[80:83], a[208:211], a[0:3], v[80:83]
    ds_read_b128 a[28:31], v23 offset:64512
    v_mfma_f32_16x16x32_bf16 v[104:107], a[212:215], a[0:3], v[104:107]
    buffer_load_dwordx4 v23, s[40:43], s58 offen offset:2048 sc1 lds
    s_waitcnt lgkmcnt(6)
    v_mfma_f32_16x16x32_bf16 v[84:87], a[208:211], a[4:7], v[84:87]
    ds_read_b128 a[32:35], v192 offset:0
    v_mfma_f32_16x16x32_bf16 v[108:111], a[212:215], a[4:7], v[108:111]
    ds_read_b128 a[36:39], v192 offset:1024
    s_waitcnt lgkmcnt(7)
    v_mfma_f32_16x16x32_bf16 v[88:91], a[208:211], a[8:11], v[88:91]
    ds_read_b128 a[40:43], v192 offset:2048
    v_mfma_f32_16x16x32_bf16 v[112:115], a[212:215], a[8:11], v[112:115]
    buffer_load_dwordx4 v23, s[40:43], s58 offen offset:3072 sc1 lds
    s_waitcnt lgkmcnt(7)
    v_mfma_f32_16x16x32_bf16 v[92:95], a[208:211], a[12:15], v[92:95]
    s_add_u32 m0, s75, 4096
    s_add_u32 s58, s58, 4096
    v_mfma_f32_16x16x32_bf16 v[116:119], a[212:215], a[12:15], v[116:119]
    s_add_u32 s74, s48, 12
    s_mul_i32 s75, s48, 6144
    s_waitcnt lgkmcnt(6)
    v_mfma_f32_16x16x32_bf16 v[96:99], a[208:211], a[16:19], v[96:99]
    ds_read_b128 a[44:47], v192 offset:3072
    v_mfma_f32_16x16x32_bf16 v[120:123], a[212:215], a[16:19], v[120:123]
    buffer_load_dwordx4 v23, s[40:43], s58 offen offset:0 sc1 lds
    s_waitcnt lgkmcnt(6)
    v_mfma_f32_16x16x32_bf16 v[100:103], a[208:211], a[20:23], v[100:103]
    ds_read_b128 a[48:51], v192 offset:4096
    v_mfma_f32_16x16x32_bf16 v[124:127], a[212:215], a[20:23], v[124:127]
    ds_read_b128 a[52:55], v192 offset:5120
    s_waitcnt lgkmcnt(7)
    v_mfma_f32_16x16x32_bf16 v[80:83], a[216:219], a[24:27], v[80:83]
    ds_read_b128 a[56:59], v192 offset:6144
    v_mfma_f32_16x16x32_bf16 v[104:107], a[220:223], a[24:27], v[104:107]
    buffer_load_dwordx4 v23, s[40:43], s58 offen offset:1024 sc1 lds
    s_waitcnt lgkmcnt(7)
    v_mfma_f32_16x16x32_bf16 v[84:87], a[216:219], a[28:31], v[84:87]
    s_lshr_b32 s58, s74, 2
    s_add_u32 s58, s58, s85
    v_mfma_f32_16x16x32_bf16 v[108:111], a[220:223], a[28:31], v[108:111]
    s_add_u32 s76, s74, s87
    s_and_b32 s58, s58, 3
    s_waitcnt lgkmcnt(6)
    v_mfma_f32_16x16x32_bf16 v[88:91], a[216:219], a[32:35], v[88:91]
    s_lshl_b32 s58, s58, 2
    s_and_b32 s76, s76, 3
    v_mfma_f32_16x16x32_bf16 v[112:115], a[220:223], a[32:35], v[112:115]
    s_add_u32 s58, s58, s76
    s_mul_i32 s58, s58, 6144
    s_waitcnt lgkmcnt(5)
    v_mfma_f32_16x16x32_bf16 v[92:95], a[216:219], a[36:39], v[92:95]
    s_add_u32 s58, s58, s73
    s_add_u32 s58, s58, 6291456
    v_mfma_f32_16x16x32_bf16 v[116:119], a[220:223], a[36:39], v[116:119]
    s_add_u32 m0, s75, 24576
    s_nop 0
    buffer_load_dwordx4 v23, s[40:43], s58 offen offset:0 sc1 lds
    s_waitcnt lgkmcnt(4)
    v_mfma_f32_16x16x32_bf16 v[96:99], a[216:219], a[40:43], v[96:99]
    ds_read_b128 a[60:63], v192 offset:7168
    v_mfma_f32_16x16x32_bf16 v[120:123], a[220:223], a[40:43], v[120:123]
    ds_read_b128 a[64:67], v192 offset:8192
    s_waitcnt lgkmcnt(5)
    v_mfma_f32_16x16x32_bf16 v[100:103], a[216:219], a[44:47], v[100:103]
    ds_read_b128 a[68:71], v192 offset:9216
    v_mfma_f32_16x16x32_bf16 v[124:127], a[220:223], a[44:47], v[124:127]
    buffer_load_dwordx4 v23, s[40:43], s58 offen offset:1024 sc1 lds
    s_waitcnt lgkmcnt(5)
    v_mfma_f32_16x16x32_bf16 v[80:83], a[224:227], a[48:51], v[80:83]
    ds_read_b128 a[72:75], v192 offset:10240
    v_mfma_f32_16x16x32_bf16 v[104:107], a[228:231], a[48:51], v[104:107]
    ds_read_b128 a[76:79], v192 offset:11264
    s_waitcnt lgkmcnt(6)
    v_mfma_f32_16x16x32_bf16 v[84:87], a[224:227], a[52:55], v[84:87]
    ds_read_b128 a[80:83], v192 offset:12288
    v_mfma_f32_16x16x32_bf16 v[108:111], a[228:231], a[52:55], v[108:111]
    buffer_load_dwordx4 v23, s[40:43], s58 offen offset:2048 sc1 lds
    s_waitcnt lgkmcnt(6)
    v_mfma_f32_16x16x32_bf16 v[88:91], a[224:227], a[56:59], v[88:91]
    ds_read_b128 a[84:87], v192 offset:13312
    v_mfma_f32_16x16x32_bf16 v[112:115], a[228:231], a[56:59], v[112:115]
    ds_read_b128 a[88:91], v192 offset:14336
    s_waitcnt lgkmcnt(7)
    v_mfma_f32_16x16x32_bf16 v[92:95], a[224:227], a[60:63], v[92:95]
    ds_read_b128 a[92:95], v192 offset:15360
    v_mfma_f32_16x16x32_bf16 v[116:119], a[228:231], a[60:63], v[116:119]
    buffer_load_dwordx4 v23, s[40:43], s58 offen offset:3072 sc1 lds
    s_waitcnt lgkmcnt(7)
    v_mfma_f32_16x16x32_bf16 v[96:99], a[224:227], a[64:67], v[96:99]
    s_add_u32 m0, s75, 28672
    s_add_u32 s58, s58, 4096
    v_mfma_f32_16x16x32_bf16 v[120:123], a[228:231], a[64:67], v[120:123]
    s_waitcnt lgkmcnt(6)
    v_mfma_f32_16x16x32_bf16 v[100:103], a[224:227], a[68:71], v[100:103]
    v_mfma_f32_16x16x32_bf16 v[124:127], a[228:231], a[68:71], v[124:127]
    buffer_load_dwordx4 v23, s[40:43], s58 offen offset:0 sc1 lds
    s_waitcnt lgkmcnt(5)
    v_mfma_f32_16x16x32_bf16 v[80:83], a[232:235], a[72:75], v[80:83]
    v_mfma_f32_16x16x32_bf16 v[104:107], a[236:239], a[72:75], v[104:107]
    s_waitcnt lgkmcnt(4)
    v_mfma_f32_16x16x32_bf16 v[84:87], a[232:235], a[76:79], v[84:87]
    v_mfma_f32_16x16x32_bf16 v[108:111], a[236:239], a[76:79], v[108:111]
    buffer_load_dwordx4 v23, s[40:43], s58 offen offset:1024 sc1 lds
    s_waitcnt lgkmcnt(3)
    v_mfma_f32_16x16x32_bf16 v[88:91], a[232:235], a[80:83], v[88:91]
    v_mfma_f32_16x16x32_bf16 v[112:115], a[236:239], a[80:83], v[112:115]
    s_waitcnt lgkmcnt(2)
    v_mfma_f32_16x16x32_bf16 v[92:95], a[232:235], a[84:87], v[92:95]
    v_mfma_f32_16x16x32_bf16 v[116:119], a[236:239], a[84:87], v[116:119]
    s_waitcnt lgkmcnt(1)
    v_mfma_f32_16x16x32_bf16 v[96:99], a[232:235], a[88:91], v[96:99]
    v_mfma_f32_16x16x32_bf16 v[120:123], a[236:239], a[88:91], v[120:123]
    s_waitcnt lgkmcnt(0)
    v_mfma_f32_16x16x32_bf16 v[100:103], a[232:235], a[92:95], v[100:103]
    v_mfma_f32_16x16x32_bf16 v[124:127], a[236:239], a[92:95], v[124:127]
    s_waitcnt vmcnt(12)
    s_waitcnt lgkmcnt(0)
    s_barrier
    v_add_u32 v192, 0x10000, v23
    v_add_u32 v193, 0x20000, v23
    v_cvt_pk_bf16_f32 v80, v80, v81
    v_cvt_pk_bf16_f32 v81, v82, v83
    v_cvt_pk_bf16_f32 v82, v104, v105
    v_cvt_pk_bf16_f32 v83, v106, v107
    s_add_u32 s58, s88, 0
    buffer_store_dwordx4 v[80:83], v23, s[40:43], s58 offen sc1
    v_cvt_pk_bf16_f32 v84, v84, v85
    v_cvt_pk_bf16_f32 v85, v86, v87
    v_cvt_pk_bf16_f32 v86, v108, v109
    v_cvt_pk_bf16_f32 v87, v110, v111
    s_add_u32 s58, s88, 1024
    v_cvt_pk_bf16_f32 v88, v88, v89
    v_cvt_pk_bf16_f32 v89, v90, v91
    v_cvt_pk_bf16_f32 v90, v112, v113
    v_cvt_pk_bf16_f32 v91, v114, v115
    v_cvt_pk_bf16_f32 v92, v92, v93
    v_cvt_pk_bf16_f32 v93, v94, v95
    v_cvt_pk_bf16_f32 v94, v116, v117
    v_cvt_pk_bf16_f32 v95, v118, v119
    v_cvt_pk_bf16_f32 v96, v96, v97
    buffer_store_dwordx4 v[84:87], v23, s[40:43], s58 offen sc1
    s_add_u32 s58, s88, 2048
    v_cvt_pk_bf16_f32 v97, v98, v99
    v_cvt_pk_bf16_f32 v98, v120, v121
    v_cvt_pk_bf16_f32 v99, v122, v123
    v_cvt_pk_bf16_f32 v100, v100, v101
    v_cvt_pk_bf16_f32 v101, v102, v103
    v_cvt_pk_bf16_f32 v102, v124, v125
    v_cvt_pk_bf16_f32 v103, v126, v127
    ds_read_b128 a[0:3], v192 offset:32768
    ds_read_b128 a[4:7], v192 offset:33792
    buffer_store_dwordx4 v[88:91], v23, s[40:43], s58 offen sc1
    s_add_u32 s58, s88, 3072
    ds_read_b128 a[8:11], v192 offset:34816
    ds_read_b128 a[12:15], v192 offset:35840
    ds_read_b128 a[16:19], v192 offset:36864
    ds_read_b128 a[20:23], v192 offset:37888
    buffer_store_dwordx4 v[92:95], v23, s[40:43], s58 offen sc1
    s_waitcnt lgkmcnt(5)
    v_mfma_f32_16x16x32_bf16 v[128:131], a[112:115], a[0:3], 0
    s_add_u32 s58, s88, 4096
    ds_read_b128 a[24:27], v192 offset:38912
    v_mfma_f32_16x16x32_bf16 v[152:155], a[116:119], a[0:3], 0
    ds_read_b128 a[28:31], v192 offset:39936
    s_waitcnt lgkmcnt(6)
    v_mfma_f32_16x16x32_bf16 v[132:135], a[112:115], a[4:7], 0
    ds_read_b128 a[32:35], v192 offset:40960
    v_mfma_f32_16x16x32_bf16 v[156:159], a[116:119], a[4:7], 0
    buffer_store_dwordx4 v[96:99], v23, s[40:43], s58 offen sc1
    s_waitcnt lgkmcnt(6)
    v_mfma_f32_16x16x32_bf16 v[136:139], a[112:115], a[8:11], 0
    s_add_u32 s58, s88, 5120
    ds_read_b128 a[36:39], v192 offset:41984
    v_mfma_f32_16x16x32_bf16 v[160:163], a[116:119], a[8:11], 0
    ds_read_b128 a[40:43], v192 offset:43008
    s_waitcnt lgkmcnt(7)
    v_mfma_f32_16x16x32_bf16 v[140:143], a[112:115], a[12:15], 0
    ds_read_b128 a[44:47], v192 offset:44032
    v_mfma_f32_16x16x32_bf16 v[164:167], a[116:119], a[12:15], 0
    buffer_store_dwordx4 v[100:103], v23, s[40:43], s58 offen sc1
    s_waitcnt lgkmcnt(7)
    v_mfma_f32_16x16x32_bf16 v[144:147], a[112:115], a[16:19], 0
    ds_read_b128 a[48:51], v192 offset:45056
    v_mfma_f32_16x16x32_bf16 v[168:171], a[116:119], a[16:19], 0
    ds_read_b128 a[52:55], v192 offset:46080
    s_waitcnt lgkmcnt(8)
    v_mfma_f32_16x16x32_bf16 v[148:151], a[112:115], a[20:23], 0
    ds_read_b128 a[56:59], v192 offset:47104
    v_mfma_f32_16x16x32_bf16 v[172:175], a[116:119], a[20:23], 0
    ds_read_b128 a[60:63], v192 offset:48128
    s_waitcnt lgkmcnt(9)
    v_mfma_f32_16x16x32_bf16 v[128:131], a[120:123], a[24:27], v[128:131]
    ds_read_b128 a[64:67], v192 offset:49152
    v_mfma_f32_16x16x32_bf16 v[152:155], a[124:127], a[24:27], v[152:155]
    ds_read_b128 a[68:71], v192 offset:50176
    s_waitcnt lgkmcnt(10)
    v_mfma_f32_16x16x32_bf16 v[132:135], a[120:123], a[28:31], v[132:135]
    ds_read_b128 a[72:75], v192 offset:51200
    v_mfma_f32_16x16x32_bf16 v[156:159], a[124:127], a[28:31], v[156:159]
    ds_read_b128 a[76:79], v192 offset:52224
    s_waitcnt lgkmcnt(11)
    v_mfma_f32_16x16x32_bf16 v[136:139], a[120:123], a[32:35], v[136:139]
    ds_read_b128 a[80:83], v192 offset:53248
    v_mfma_f32_16x16x32_bf16 v[160:163], a[124:127], a[32:35], v[160:163]
    ds_read_b128 a[84:87], v192 offset:54272
    s_waitcnt lgkmcnt(12)
    v_mfma_f32_16x16x32_bf16 v[140:143], a[120:123], a[36:39], v[140:143]
    ds_read_b128 a[88:91], v192 offset:55296
    v_mfma_f32_16x16x32_bf16 v[164:167], a[124:127], a[36:39], v[164:167]
    ds_read_b128 a[92:95], v192 offset:56320
    s_waitcnt lgkmcnt(13)
    v_mfma_f32_16x16x32_bf16 v[144:147], a[120:123], a[40:43], v[144:147]
    ds_read_b128 a[0:3], v192 offset:57344
    v_mfma_f32_16x16x32_bf16 v[168:171], a[124:127], a[40:43], v[168:171]
    ds_read_b128 a[4:7], v192 offset:58368
    s_waitcnt lgkmcnt(14)
    v_mfma_f32_16x16x32_bf16 v[148:151], a[120:123], a[44:47], v[148:151]
    ds_read_b128 a[8:11], v192 offset:59392
    v_mfma_f32_16x16x32_bf16 v[172:175], a[124:127], a[44:47], v[172:175]
    ds_read_b128 a[12:15], v192 offset:60416
    s_waitcnt lgkmcnt(15)
    v_mfma_f32_16x16x32_bf16 v[128:131], a[128:131], a[48:51], v[128:131]
    ds_read_b128 a[16:19], v192 offset:61440
    v_mfma_f32_16x16x32_bf16 v[152:155], a[132:135], a[48:51], v[152:155]
    ds_read_b128 a[20:23], v192 offset:62464
    s_waitcnt lgkmcnt(15)
    v_mfma_f32_16x16x32_bf16 v[132:135], a[128:131], a[52:55], v[132:135]
    ds_read_b128 a[24:27], v192 offset:63488
    v_mfma_f32_16x16x32_bf16 v[156:159], a[132:135], a[52:55], v[156:159]
    ds_read_b128 a[28:31], v192 offset:64512
    v_mfma_f32_16x16x32_bf16 v[136:139], a[128:131], a[56:59], v[136:139]
    ds_read_b128 a[32:35], v193 offset:0
    v_mfma_f32_16x16x32_bf16 v[160:163], a[132:135], a[56:59], v[160:163]
    ds_read_b128 a[36:39], v193 offset:1024
    s_waitcnt lgkmcnt(15)
    v_mfma_f32_16x16x32_bf16 v[140:143], a[128:131], a[60:63], v[140:143]
    ds_read_b128 a[40:43], v193 offset:2048
    v_mfma_f32_16x16x32_bf16 v[164:167], a[132:135], a[60:63], v[164:167]
    ds_read_b128 a[44:47], v193 offset:3072
    v_mfma_f32_16x16x32_bf16 v[144:147], a[128:131], a[64:67], v[144:147]
    ds_read_b128 a[48:51], v193 offset:4096
    v_mfma_f32_16x16x32_bf16 v[168:171], a[132:135], a[64:67], v[168:171]
    ds_read_b128 a[52:55], v193 offset:5120
    v_mfma_f32_16x16x32_bf16 v[148:151], a[128:131], a[68:71], v[148:151]
    ds_read_b128 a[56:59], v193 offset:6144
    v_mfma_f32_16x16x32_bf16 v[172:175], a[132:135], a[68:71], v[172:175]
    ds_read_b128 a[60:63], v193 offset:7168
    v_mfma_f32_16x16x32_bf16 v[128:131], a[136:139], a[72:75], v[128:131]
    ds_read_b128 a[64:67], v193 offset:8192
    v_mfma_f32_16x16x32_bf16 v[152:155], a[140:143], a[72:75], v[152:155]
    ds_read_b128 a[68:71], v193 offset:9216
    s_waitcnt lgkmcnt(15)
    v_mfma_f32_16x16x32_bf16 v[132:135], a[136:139], a[76:79], v[132:135]
    ds_read_b128 a[72:75], v193 offset:10240
    v_mfma_f32_16x16x32_bf16 v[156:159], a[140:143], a[76:79], v[156:159]
    ds_read_b128 a[76:79], v193 offset:11264
    v_mfma_f32_16x16x32_bf16 v[136:139], a[136:139], a[80:83], v[136:139]
    v_mfma_f32_16x16x32_bf16 v[160:163], a[140:143], a[80:83], v[160:163]
    ds_read_b128 a[80:83], v193 offset:12288
    v_mfma_f32_16x16x32_bf16 v[140:143], a[136:139], a[84:87], v[140:143]
    v_mfma_f32_16x16x32_bf16 v[164:167], a[140:143], a[84:87], v[164:167]
    ds_read_b128 a[84:87], v193 offset:13312
    v_mfma_f32_16x16x32_bf16 v[144:147], a[136:139], a[88:91], v[144:147]
    v_mfma_f32_16x16x32_bf16 v[168:171], a[140:143], a[88:91], v[168:171]
    ds_read_b128 a[88:91], v193 offset:14336
    v_mfma_f32_16x16x32_bf16 v[148:151], a[136:139], a[92:95], v[148:151]
    v_mfma_f32_16x16x32_bf16 v[172:175], a[140:143], a[92:95], v[172:175]
    ds_read_b128 a[92:95], v193 offset:15360
    v_mfma_f32_16x16x32_bf16 v[128:131], a[144:147], a[0:3], v[128:131]
    v_mfma_f32_16x16x32_bf16 v[152:155], a[148:151], a[0:3], v[152:155]
    v_mfma_f32_16x16x32_bf16 v[132:135], a[144:147], a[4:7], v[132:135]
    v_mfma_f32_16x16x32_bf16 v[156:159], a[148:151], a[4:7], v[156:159]
    v_mfma_f32_16x16x32_bf16 v[136:139], a[144:147], a[8:11], v[136:139]
    v_mfma_f32_16x16x32_bf16 v[160:163], a[148:151], a[8:11], v[160:163]
    s_waitcnt lgkmcnt(15)
    v_mfma_f32_16x16x32_bf16 v[140:143], a[144:147], a[12:15], v[140:143]
    v_mfma_f32_16x16x32_bf16 v[164:167], a[148:151], a[12:15], v[164:167]
    v_mfma_f32_16x16x32_bf16 v[144:147], a[144:147], a[16:19], v[144:147]
    v_mfma_f32_16x16x32_bf16 v[168:171], a[148:151], a[16:19], v[168:171]
    v_mfma_f32_16x16x32_bf16 v[148:151], a[144:147], a[20:23], v[148:151]
    v_mfma_f32_16x16x32_bf16 v[172:175], a[148:151], a[20:23], v[172:175]
    v_mfma_f32_16x16x32_bf16 v[128:131], a[152:155], a[24:27], v[128:131]
    v_mfma_f32_16x16x32_bf16 v[152:155], a[156:159], a[24:27], v[152:155]
    v_mfma_f32_16x16x32_bf16 v[132:135], a[152:155], a[28:31], v[132:135]
    v_mfma_f32_16x16x32_bf16 v[156:159], a[156:159], a[28:31], v[156:159]
    v_mfma_f32_16x16x32_bf16 v[136:139], a[152:155], a[32:35], v[136:139]
    v_mfma_f32_16x16x32_bf16 v[160:163], a[156:159], a[32:35], v[160:163]
    s_waitcnt lgkmcnt(14)
    v_mfma_f32_16x16x32_bf16 v[140:143], a[152:155], a[36:39], v[140:143]
    v_mfma_f32_16x16x32_bf16 v[164:167], a[156:159], a[36:39], v[164:167]
    s_waitcnt lgkmcnt(13)
    v_mfma_f32_16x16x32_bf16 v[144:147], a[152:155], a[40:43], v[144:147]
    v_mfma_f32_16x16x32_bf16 v[168:171], a[156:159], a[40:43], v[168:171]
    s_waitcnt lgkmcnt(12)
    v_mfma_f32_16x16x32_bf16 v[148:151], a[152:155], a[44:47], v[148:151]
    v_mfma_f32_16x16x32_bf16 v[172:175], a[156:159], a[44:47], v[172:175]
    s_waitcnt lgkmcnt(11)
    v_mfma_f32_16x16x32_bf16 v[128:131], a[160:163], a[48:51], v[128:131]
    v_mfma_f32_16x16x32_bf16 v[152:155], a[164:167], a[48:51], v[152:155]
    s_waitcnt lgkmcnt(10)
    v_mfma_f32_16x16x32_bf16 v[132:135], a[160:163], a[52:55], v[132:135]
    v_mfma_f32_16x16x32_bf16 v[156:159], a[164:167], a[52:55], v[156:159]
    s_waitcnt lgkmcnt(9)
    v_mfma_f32_16x16x32_bf16 v[136:139], a[160:163], a[56:59], v[136:139]
    v_mfma_f32_16x16x32_bf16 v[160:163], a[164:167], a[56:59], v[160:163]
    s_waitcnt lgkmcnt(8)
    v_mfma_f32_16x16x32_bf16 v[140:143], a[160:163], a[60:63], v[140:143]
    v_mfma_f32_16x16x32_bf16 v[164:167], a[164:167], a[60:63], v[164:167]
    s_waitcnt lgkmcnt(7)
    v_mfma_f32_16x16x32_bf16 v[144:147], a[160:163], a[64:67], v[144:147]
    v_mfma_f32_16x16x32_bf16 v[168:171], a[164:167], a[64:67], v[168:171]
    s_waitcnt lgkmcnt(6)
    v_mfma_f32_16x16x32_bf16 v[148:151], a[160:163], a[68:71], v[148:151]
    v_mfma_f32_16x16x32_bf16 v[172:175], a[164:167], a[68:71], v[172:175]
    s_waitcnt lgkmcnt(5)
    v_mfma_f32_16x16x32_bf16 v[128:131], a[168:171], a[72:75], v[128:131]
    v_mfma_f32_16x16x32_bf16 v[152:155], a[172:175], a[72:75], v[152:155]
    s_waitcnt lgkmcnt(4)
    v_mfma_f32_16x16x32_bf16 v[132:135], a[168:171], a[76:79], v[132:135]
    v_mfma_f32_16x16x32_bf16 v[156:159], a[172:175], a[76:79], v[156:159]
    s_waitcnt lgkmcnt(3)
    v_mfma_f32_16x16x32_bf16 v[136:139], a[168:171], a[80:83], v[136:139]
    v_mfma_f32_16x16x32_bf16 v[160:163], a[172:175], a[80:83], v[160:163]
    s_waitcnt lgkmcnt(2)
    v_mfma_f32_16x16x32_bf16 v[140:143], a[168:171], a[84:87], v[140:143]
    v_mfma_f32_16x16x32_bf16 v[164:167], a[172:175], a[84:87], v[164:167]
    s_waitcnt lgkmcnt(1)
    v_mfma_f32_16x16x32_bf16 v[144:147], a[168:171], a[88:91], v[144:147]
    v_mfma_f32_16x16x32_bf16 v[168:171], a[172:175], a[88:91], v[168:171]
    s_waitcnt lgkmcnt(0)
    v_mfma_f32_16x16x32_bf16 v[148:151], a[168:171], a[92:95], v[148:151]
    v_mfma_f32_16x16x32_bf16 v[172:175], a[172:175], a[92:95], v[172:175]
    s_waitcnt vmcnt(6)
    s_waitcnt lgkmcnt(0)
    s_barrier
    v_add_u32 v192, 0x10000, v23
    v_add_u32 v193, 0x20000, v23
    ds_read_b128 a[0:3], v23 offset:0
    ds_read_b128 a[4:7], v23 offset:1024
    ds_read_b128 a[8:11], v23 offset:2048
    ds_read_b128 a[12:15], v23 offset:3072
    ds_read_b128 a[16:19], v23 offset:4096
    ds_read_b128 a[20:23], v23 offset:5120
    ds_read_b128 a[24:27], v23 offset:6144
    s_waitcnt lgkmcnt(6)
    v_mfma_f32_16x16x32_bf16 v[128:131], a[176:179], a[0:3], v[128:131]
    ds_read_b128 a[28:31], v23 offset:7168
    v_mfma_f32_16x16x32_bf16 v[152:155], a[180:183], a[0:3], v[152:155]
    ds_read_b128 a[32:35], v23 offset:8192
    s_waitcnt lgkmcnt(7)
    v_mfma_f32_16x16x32_bf16 v[132:135], a[176:179], a[4:7], v[132:135]
    ds_read_b128 a[36:39], v23 offset:9216
    v_mfma_f32_16x16x32_bf16 v[156:159], a[180:183], a[4:7], v[156:159]
    ds_read_b128 a[40:43], v23 offset:10240
    s_waitcnt lgkmcnt(8)
    v_mfma_f32_16x16x32_bf16 v[136:139], a[176:179], a[8:11], v[136:139]
    ds_read_b128 a[44:47], v23 offset:11264
    v_mfma_f32_16x16x32_bf16 v[160:163], a[180:183], a[8:11], v[160:163]
    ds_read_b128 a[48:51], v23 offset:12288
    s_waitcnt lgkmcnt(9)
    v_mfma_f32_16x16x32_bf16 v[140:143], a[176:179], a[12:15], v[140:143]
    ds_read_b128 a[52:55], v23 offset:13312
    v_mfma_f32_16x16x32_bf16 v[164:167], a[180:183], a[12:15], v[164:167]
    ds_read_b128 a[56:59], v23 offset:14336
    s_waitcnt lgkmcnt(10)
    v_mfma_f32_16x16x32_bf16 v[144:147], a[176:179], a[16:19], v[144:147]
    ds_read_b128 a[60:63], v23 offset:15360
    v_mfma_f32_16x16x32_bf16 v[168:171], a[180:183], a[16:19], v[168:171]
    ds_read_b128 a[64:67], v23 offset:16384
    s_waitcnt lgkmcnt(11)
    v_mfma_f32_16x16x32_bf16 v[148:151], a[176:179], a[20:23], v[148:151]
    ds_read_b128 a[68:71], v23 offset:17408
    v_mfma_f32_16x16x32_bf16 v[172:175], a[180:183], a[20:23], v[172:175]
    ds_read_b128 a[72:75], v23 offset:18432
    s_waitcnt lgkmcnt(12)
    v_mfma_f32_16x16x32_bf16 v[128:131], a[184:187], a[24:27], v[128:131]
    ds_read_b128 a[76:79], v23 offset:19456
    v_mfma_f32_16x16x32_bf16 v[152:155], a[188:191], a[24:27], v[152:155]
    ds_read_b128 a[80:83], v23 offset:20480
    s_waitcnt lgkmcnt(13)
    v_mfma_f32_16x16x32_bf16 v[132:135], a[184:187], a[28:31], v[132:135]
    ds_read_b128 a[84:87], v23 offset:21504
    v_mfma_f32_16x16x32_bf16 v[156:159], a[188:191], a[28:31], v[156:159]
    ds_read_b128 a[88:91], v23 offset:22528
    s_waitcnt lgkmcnt(14)
    v_mfma_f32_16x16x32_bf16 v[136:139], a[184:187], a[32:35], v[136:139]
    ds_read_b128 a[92:95], v23 offset:23552
    v_mfma_f32_16x16x32_bf16 v[160:163], a[188:191], a[32:35], v[160:163]
    s_waitcnt lgkmcnt(14)
    v_mfma_f32_16x16x32_bf16 v[140:143], a[184:187], a[36:39], v[140:143]
    v_mfma_f32_16x16x32_bf16 v[164:167], a[188:191], a[36:39], v[164:167]
    s_waitcnt lgkmcnt(13)
    v_mfma_f32_16x16x32_bf16 v[144:147], a[184:187], a[40:43], v[144:147]
    v_mfma_f32_16x16x32_bf16 v[168:171], a[188:191], a[40:43], v[168:171]
    s_waitcnt lgkmcnt(12)
    v_mfma_f32_16x16x32_bf16 v[148:151], a[184:187], a[44:47], v[148:151]
    v_mfma_f32_16x16x32_bf16 v[172:175], a[188:191], a[44:47], v[172:175]
    s_waitcnt lgkmcnt(11)
    v_mfma_f32_16x16x32_bf16 v[128:131], a[192:195], a[48:51], v[128:131]
    v_mfma_f32_16x16x32_bf16 v[152:155], a[196:199], a[48:51], v[152:155]
    s_waitcnt lgkmcnt(10)
    v_mfma_f32_16x16x32_bf16 v[132:135], a[192:195], a[52:55], v[132:135]
    v_mfma_f32_16x16x32_bf16 v[156:159], a[196:199], a[52:55], v[156:159]
    s_waitcnt lgkmcnt(9)
    v_mfma_f32_16x16x32_bf16 v[136:139], a[192:195], a[56:59], v[136:139]
    v_mfma_f32_16x16x32_bf16 v[160:163], a[196:199], a[56:59], v[160:163]
    s_waitcnt lgkmcnt(8)
    v_mfma_f32_16x16x32_bf16 v[140:143], a[192:195], a[60:63], v[140:143]
    v_mfma_f32_16x16x32_bf16 v[164:167], a[196:199], a[60:63], v[164:167]
    s_waitcnt lgkmcnt(7)
    v_mfma_f32_16x16x32_bf16 v[144:147], a[192:195], a[64:67], v[144:147]
    v_mfma_f32_16x16x32_bf16 v[168:171], a[196:199], a[64:67], v[168:171]
    s_waitcnt lgkmcnt(6)
    v_mfma_f32_16x16x32_bf16 v[148:151], a[192:195], a[68:71], v[148:151]
    v_mfma_f32_16x16x32_bf16 v[172:175], a[196:199], a[68:71], v[172:175]
    s_waitcnt lgkmcnt(5)
    v_mfma_f32_16x16x32_bf16 v[128:131], a[200:203], a[72:75], v[128:131]
    v_mfma_f32_16x16x32_bf16 v[152:155], a[204:207], a[72:75], v[152:155]
    s_waitcnt lgkmcnt(4)
    v_mfma_f32_16x16x32_bf16 v[132:135], a[200:203], a[76:79], v[132:135]
    v_mfma_f32_16x16x32_bf16 v[156:159], a[204:207], a[76:79], v[156:159]
    s_waitcnt lgkmcnt(3)
    v_mfma_f32_16x16x32_bf16 v[136:139], a[200:203], a[80:83], v[136:139]
    v_mfma_f32_16x16x32_bf16 v[160:163], a[204:207], a[80:83], v[160:163]
    s_waitcnt lgkmcnt(2)
    v_mfma_f32_16x16x32_bf16 v[140:143], a[200:203], a[84:87], v[140:143]
    v_mfma_f32_16x16x32_bf16 v[164:167], a[204:207], a[84:87], v[164:167]
    s_waitcnt lgkmcnt(1)
    v_mfma_f32_16x16x32_bf16 v[144:147], a[200:203], a[88:91], v[144:147]
    v_mfma_f32_16x16x32_bf16 v[168:171], a[204:207], a[88:91], v[168:171]
    s_waitcnt lgkmcnt(0)
    v_mfma_f32_16x16x32_bf16 v[148:151], a[200:203], a[92:95], v[148:151]
    v_mfma_f32_16x16x32_bf16 v[172:175], a[204:207], a[92:95], v[172:175]
    s_waitcnt vmcnt(0)
    s_barrier
    s_cmp_lg_u32 s48, 0
    s_cbranch_scc1 L_w0_33
    v_mov_b32 v204, 1
    v_mov_b32 v205, 0
    s_mov_b64 exec, 1
    s_lshl_b32 s59, s84, 2
    s_add_u32 s59, s59, s63
    buffer_store_dword v204, v205, s[40:43], s59 offen sc1
    s_mov_b64 exec, -1
L_w0_33:
    v_add_u32 v192, 0x10000, v23
    v_add_u32 v193, 0x20000, v23
    ds_read_b128 a[0:3], v23 offset:24576
    s_add_u32 s58, s88, 6291456
    ds_read_b128 a[16:19], v23 offset:25600
    ds_read_b128 a[4:7], v23 offset:30720
    ds_read_b128 a[32:35], v23 offset:26624
    ds_read_b128 a[20:23], v23 offset:31744
    ds_read_b128 a[8:11], v23 offset:36864
    ds_read_b128 a[48:51], v23 offset:27648
    s_waitcnt lgkmcnt(6)
    v_mfma_f32_16x16x32_bf16 v[128:131], a[208:211], a[0:3], v[128:131]
    ds_read_b128 a[36:39], v23 offset:32768
    v_mfma_f32_16x16x32_bf16 v[152:155], a[212:215], a[0:3], v[152:155]
    ds_read_b128 a[24:27], v23 offset:37888
    s_waitcnt lgkmcnt(6)
    v_mfma_f32_16x16x32_bf16 v[128:131], a[216:219], a[4:7], v[128:131]
    ds_read_b128 a[12:15], v23 offset:43008
    v_mfma_f32_16x16x32_bf16 v[152:155], a[220:223], a[4:7], v[152:155]
    ds_read_b128 a[64:67], v23 offset:28672
    v_mfma_f32_16x16x32_bf16 v[132:135], a[208:211], a[16:19], v[132:135]
    ds_read_b128 a[52:55], v23 offset:33792
    s_waitcnt lgkmcnt(6)
    v_mfma_f32_16x16x32_bf16 v[128:131], a[224:227], a[8:11], v[128:131]
    ds_read_b128 a[40:43], v23 offset:38912
    v_mfma_f32_16x16x32_bf16 v[152:155], a[228:231], a[8:11], v[152:155]
    ds_read_b128 a[28:31], v23 offset:44032
    v_mfma_f32_16x16x32_bf16 v[156:159], a[212:215], a[16:19], v[156:159]
    ds_read_b128 a[80:83], v23 offset:29696
    v_mfma_f32_16x16x32_bf16 v[132:135], a[216:219], a[20:23], v[132:135]
    ds_read_b128 a[68:71], v23 offset:34816
    s_waitcnt lgkmcnt(6)
    v_mfma_f32_16x16x32_bf16 v[128:131], a[232:235], a[12:15], v[128:131]
    ds_read_b128 a[56:59], v23 offset:39936
    v_mfma_f32_16x16x32_bf16 v[152:155], a[236:239], a[12:15], v[152:155]
    ds_read_b128 a[44:47], v23 offset:45056
    v_mfma_f32_16x16x32_bf16 v[156:159], a[220:223], a[20:23], v[156:159]
    s_nop 3
    v_cvt_pk_bf16_f32 v128, v128, v129
    v_cvt_pk_bf16_f32 v129, v130, v131
    v_mfma_f32_16x16x32_bf16 v[132:135], a[224:227], a[24:27], v[132:135]
    v_cvt_pk_bf16_f32 v130, v152, v153
    v_cvt_pk_bf16_f32 v131, v154, v155
    v_mfma_f32_16x16x32_bf16 v[156:159], a[228:231], a[24:27], v[156:159]
    buffer_store_dwordx4 v[128:131], v23, s[40:43], s58 offen sc1
    s_waitcnt lgkmcnt(4)
    v_mfma_f32_16x16x32_bf16 v[132:135], a[232:235], a[28:31], v[132:135]
    s_add_u32 s58, s88, 6292480
    ds_read_b128 a[60:63], v23 offset:46080
    v_mfma_f32_16x16x32_bf16 v[156:159], a[236:239], a[28:31], v[156:159]
    ds_read_b128 a[84:87], v23 offset:35840
    v_mfma_f32_16x16x32_bf16 v[136:139], a[208:211], a[32:35], v[136:139]
    s_nop 2
    v_cvt_pk_bf16_f32 v132, v132, v133
    v_cvt_pk_bf16_f32 v133, v134, v135
    v_mfma_f32_16x16x32_bf16 v[160:163], a[212:215], a[32:35], v[160:163]
    v_cvt_pk_bf16_f32 v134, v156, v157
    v_cvt_pk_bf16_f32 v135, v158, v159
    v_mfma_f32_16x16x32_bf16 v[136:139], a[216:219], a[36:39], v[136:139]
    buffer_store_dwordx4 v[132:135], v23, s[40:43], s58 offen sc1
    v_mfma_f32_16x16x32_bf16 v[160:163], a[220:223], a[36:39], v[160:163]
    s_add_u32 s58, s88, 6293504
    ds_read_b128 a[72:75], v23 offset:40960
    v_mfma_f32_16x16x32_bf16 v[136:139], a[224:227], a[40:43], v[136:139]
    ds_read_b128 a[88:91], v23 offset:41984
    v_mfma_f32_16x16x32_bf16 v[160:163], a[228:231], a[40:43], v[160:163]
    ds_read_b128 a[76:79], v23 offset:47104
    s_waitcnt lgkmcnt(5)
    v_mfma_f32_16x16x32_bf16 v[136:139], a[232:235], a[44:47], v[136:139]
    ds_read_b128 a[92:95], v23 offset:48128
    v_mfma_f32_16x16x32_bf16 v[160:163], a[236:239], a[44:47], v[160:163]
    v_mfma_f32_16x16x32_bf16 v[140:143], a[208:211], a[48:51], v[140:143]
    s_nop 4
    v_cvt_pk_bf16_f32 v136, v136, v137
    v_cvt_pk_bf16_f32 v137, v138, v139
    v_mfma_f32_16x16x32_bf16 v[164:167], a[212:215], a[48:51], v[164:167]
    v_cvt_pk_bf16_f32 v138, v160, v161
    v_cvt_pk_bf16_f32 v139, v162, v163
    v_mfma_f32_16x16x32_bf16 v[140:143], a[216:219], a[52:55], v[140:143]
    buffer_store_dwordx4 v[136:139], v23, s[40:43], s58 offen sc1
    v_mfma_f32_16x16x32_bf16 v[164:167], a[220:223], a[52:55], v[164:167]
    s_add_u32 s58, s88, 6294528
    v_mfma_f32_16x16x32_bf16 v[144:147], a[208:211], a[64:67], v[144:147]
    v_mfma_f32_16x16x32_bf16 v[168:171], a[212:215], a[64:67], v[168:171]
    v_mfma_f32_16x16x32_bf16 v[148:151], a[208:211], a[80:83], v[148:151]
    v_mfma_f32_16x16x32_bf16 v[144:147], a[216:219], a[68:71], v[144:147]
    v_mfma_f32_16x16x32_bf16 v[140:143], a[224:227], a[56:59], v[140:143]
    v_mfma_f32_16x16x32_bf16 v[172:175], a[212:215], a[80:83], v[172:175]
    v_mfma_f32_16x16x32_bf16 v[168:171], a[220:223], a[68:71], v[168:171]
    v_mfma_f32_16x16x32_bf16 v[164:167], a[228:231], a[56:59], v[164:167]
    s_waitcnt lgkmcnt(4)
    v_mfma_f32_16x16x32_bf16 v[148:151], a[216:219], a[84:87], v[148:151]
    s_waitcnt lgkmcnt(3)
    v_mfma_f32_16x16x32_bf16 v[144:147], a[224:227], a[72:75], v[144:147]
    v_mfma_f32_16x16x32_bf16 v[140:143], a[232:235], a[60:63], v[140:143]
    v_mfma_f32_16x16x32_bf16 v[172:175], a[220:223], a[84:87], v[172:175]
    v_mfma_f32_16x16x32_bf16 v[168:171], a[228:231], a[72:75], v[168:171]
    s_nop 5
    v_cvt_pk_bf16_f32 v140, v140, v141
    v_cvt_pk_bf16_f32 v141, v142, v143
    v_mfma_f32_16x16x32_bf16 v[164:167], a[236:239], a[60:63], v[164:167]
    s_waitcnt lgkmcnt(2)
    v_mfma_f32_16x16x32_bf16 v[148:151], a[224:227], a[88:91], v[148:151]
    s_waitcnt lgkmcnt(1)
    v_mfma_f32_16x16x32_bf16 v[144:147], a[232:235], a[76:79], v[144:147]
    s_nop 3
    v_cvt_pk_bf16_f32 v142, v164, v165
    v_cvt_pk_bf16_f32 v143, v166, v167
    v_mfma_f32_16x16x32_bf16 v[168:171], a[236:239], a[76:79], v[168:171]
    buffer_store_dwordx4 v[140:143], v23, s[40:43], s58 offen sc1
    v_mfma_f32_16x16x32_bf16 v[172:175], a[228:231], a[88:91], v[172:175]
    v_cvt_pk_bf16_f32 v144, v144, v145
    v_cvt_pk_bf16_f32 v145, v146, v147
    s_waitcnt lgkmcnt(0)
    v_mfma_f32_16x16x32_bf16 v[148:151], a[232:235], a[92:95], v[148:151]
    s_nop 1
    v_cvt_pk_bf16_f32 v146, v168, v169
    v_cvt_pk_bf16_f32 v147, v170, v171
    v_mfma_f32_16x16x32_bf16 v[172:175], a[236:239], a[92:95], v[172:175]
    s_add_u32 s58, s88, 6295552
    buffer_store_dwordx4 v[144:147], v23, s[40:43], s58 offen sc1
    s_nop 0
    v_cvt_pk_bf16_f32 v148, v148, v149
    v_cvt_pk_bf16_f32 v149, v150, v151
    s_nop 2
    v_cvt_pk_bf16_f32 v150, v172, v173
    v_cvt_pk_bf16_f32 v151, v174, v175
    s_add_u32 s58, s88, 6296576
    buffer_store_dwordx4 v[148:151], v23, s[40:43], s58 offen sc1
    s_cmp_eq_u32 s48, 3
    s_cbranch_scc1 L_skip_34
    v_and_b32 v205, 7, v0
    v_lshlrev_b32 v205, 2, v205
    s_mov_b32 s59, s63
    buffer_load_dword v207, v205, s[40:43], s59 offen sc1
    v_and_b32 v205, 7, v0
    v_lshlrev_b32 v205, 2, v205
    s_add_u32 s59, s63, 4096
    buffer_load_dword v206, v205, s[40:43], s59 offen sc1
L_skip_34:
    s_waitcnt vmcnt(0)
    s_barrier
    s_cmp_lg_u32 s48, 3
    s_cbranch_scc1 L_w0_35
    v_mov_b32 v204, 1
    v_mov_b32 v205, 0
    s_mov_b64 exec, 1
    s_lshl_b32 s59, s84, 2
    s_add_u32 s59, s59, s63
    s_add_u32 s59, s59, 4096
    buffer_store_dword v204, v205, s[40:43], s59 offen sc1
    s_mov_b64 exec, -1
L_w0_35:
    s_cmp_eq_u32 s48, 3
    s_cbranch_scc1 L_skip_36
    v_and_b32 v204, 7, v0
    v_cmp_ne_u32 s[92:93], s84, v204
    v_cmp_ne_u32 vcc, 1, v207
    s_nop 3
    s_cbranch_vccnz L_slow_37
    v_cmp_ne_u32 vcc, 1, v206
    s_nop 3
    s_and_b64 s[92:93], vcc, s[92:93]
    s_cbranch_scc1 L_slow_37
    s_add_u32 s58, s89, 0
    buffer_load_dwordx4 v[32:35], v23, s[40:43], s58 offen sc1
    s_add_u32 s58, s89, 24576
    buffer_load_dwordx4 v[36:39], v23, s[40:43], s58 offen sc1
    s_add_u32 s58, s89, 49152
    buffer_load_dwordx4 v[40:43], v23, s[40:43], s58 offen sc1
    s_add_u32 s58, s89, 73728
    buffer_load_dwordx4 v[44:47], v23, s[40:43], s58 offen sc1
    s_add_u32 s58, s89, 98304
    buffer_load_dwordx4 v[48:51], v23, s[40:43], s58 offen sc1
    s_add_u32 s58, s89, 122880
    buffer_load_dwordx4 v[52:55], v23, s[40:43], s58 offen sc1
    s_add_u32 s58, s89, 147456
    buffer_load_dwordx4 v[56:59], v23, s[40:43], s58 offen sc1
    s_add_u32 s58, s89, 172032
    buffer_load_dwordx4 v[60:63], v23, s[40:43], s58 offen sc1
    s_add_u32 s58, s89, 6291456
    buffer_load_dwordx4 v[96:99], v23, s[40:43], s58 offen sc1
    s_add_u32 s58, s89, 6316032
    buffer_load_dwordx4 v[100:103], v23, s[40:43], s58 offen sc1
    s_add_u32 s58, s89, 6340608
    buffer_load_dwordx4 v[104:107], v23, s[40:43], s58 offen sc1
    s_add_u32 s58, s89, 6365184
    buffer_load_dwordx4 v[108:111], v23, s[40:43], s58 offen sc1
    s_add_u32 s58, s89, 6389760
    buffer_load_dwordx4 v[112:115], v23, s[40:43], s58 offen sc1
    s_add_u32 s58, s89, 6414336
    buffer_load_dwordx4 v[116:119], v23, s[40:43], s58 offen sc1
    s_add_u32 s58, s89, 6438912
    buffer_load_dwordx4 v[120:123], v23, s[40:43], s58 offen sc1
    s_add_u32 s58, s89, 6463488
    buffer_load_dwordx4 v[124:127], v23, s[40:43], s58 offen sc1
    s_waitcnt vmcnt(8)
    v_and_b32 v12, 15, v0
    v_lshrrev_b32 v13, 4, v0
    v_lshlrev_b32 v13, 3, v13
    v_lshl_add_u32 v12, v12, 10, v13
    v_lshlrev_b32 v64, 16, v32
    v_and_b32 v65, 0xffff0000, v32
    v_lshlrev_b32 v66, 16, v33
    v_and_b32 v67, 0xffff0000, v33
    v_lshlrev_b32 v68, 16, v34
    v_and_b32 v69, 0xffff0000, v34
    v_lshlrev_b32 v70, 16, v35
    v_and_b32 v71, 0xffff0000, v35
    v_lshlrev_b32 v72, 16, v36
    v_and_b32 v73, 0xffff0000, v36
    v_add_f32 v64, v64, v72
    v_add_f32 v65, v65, v73
    v_lshlrev_b32 v74, 16, v37
    v_and_b32 v75, 0xffff0000, v37
    v_add_f32 v66, v66, v74
    v_add_f32 v67, v67, v75
    v_lshlrev_b32 v76, 16, v38
    v_and_b32 v77, 0xffff0000, v38
    v_add_f32 v68, v68, v76
    v_add_f32 v69, v69, v77
    v_lshlrev_b32 v78, 16, v39
    v_and_b32 v79, 0xffff0000, v39
    v_add_f32 v70, v70, v78
    v_add_f32 v71, v71, v79
    v_lshlrev_b32 v72, 16, v40
    v_and_b32 v73, 0xffff0000, v40
    v_add_f32 v64, v64, v72
    v_add_f32 v65, v65, v73
    v_lshlrev_b32 v74, 16, v41
    v_and_b32 v75, 0xffff0000, v41
    v_add_f32 v66, v66, v74
    v_add_f32 v67, v67, v75
    v_lshlrev_b32 v76, 16, v42
    v_and_b32 v77, 0xffff0000, v42
    v_add_f32 v68, v68, v76
    v_add_f32 v69, v69, v77
    v_lshlrev_b32 v78, 16, v43
    v_and_b32 v79, 0xffff0000, v43
    v_add_f32 v70, v70, v78
    v_add_f32 v71, v71, v79
    v_lshlrev_b32 v72, 16, v44
    v_and_b32 v73, 0xffff0000, v44
    v_add_f32 v64, v64, v72
    v_add_f32 v65, v65, v73
    v_lshlrev_b32 v74, 16, v45
    v_and_b32 v75, 0xffff0000, v45
    v_add_f32 v66, v66, v74
    v_add_f32 v67, v67, v75
    v_lshlrev_b32 v76, 16, v46
    v_and_b32 v77, 0xffff0000, v46
    v_add_f32 v68, v68, v76
    v_add_f32 v69, v69, v77
    v_lshlrev_b32 v78, 16, v47
    v_and_b32 v79, 0xffff0000, v47
    v_add_f32 v70, v70, v78
    v_add_f32 v71, v71, v79
    v_lshlrev_b32 v72, 16, v48
    v_and_b32 v73, 0xffff0000, v48
    v_add_f32 v64, v64, v72
    v_add_f32 v65, v65, v73
    v_lshlrev_b32 v74, 16, v49
    v_and_b32 v75, 0xffff0000, v49
    v_add_f32 v66, v66, v74
    v_add_f32 v67, v67, v75
    v_lshlrev_b32 v76, 16, v50
    v_and_b32 v77, 0xffff0000, v50
    v_add_f32 v68, v68, v76
    v_add_f32 v69, v69, v77
    v_lshlrev_b32 v78, 16, v51
    v_and_b32 v79, 0xffff0000, v51
    v_add_f32 v70, v70, v78
    v_add_f32 v71, v71, v79
    v_lshlrev_b32 v72, 16, v52
    v_and_b32 v73, 0xffff0000, v52
    v_add_f32 v64, v64, v72
    v_add_f32 v65, v65, v73
    v_lshlrev_b32 v74, 16, v53
    v_and_b32 v75, 0xffff0000, v53
    v_add_f32 v66, v66, v74
    v_add_f32 v67, v67, v75
    v_lshlrev_b32 v76, 16, v54
    v_and_b32 v77, 0xffff0000, v54
    v_add_f32 v68, v68, v76
    v_add_f32 v69, v69, v77
    v_lshlrev_b32 v78, 16, v55
    v_and_b32 v79, 0xffff0000, v55
    v_add_f32 v70, v70, v78
    v_add_f32 v71, v71, v79
    v_lshlrev_b32 v72, 16, v56
    v_and_b32 v73, 0xffff0000, v56
    v_add_f32 v64, v64, v72
    v_add_f32 v65, v65, v73
    v_lshlrev_b32 v74, 16, v57
    v_and_b32 v75, 0xffff0000, v57
    v_add_f32 v66, v66, v74
    v_add_f32 v67, v67, v75
    v_lshlrev_b32 v76, 16, v58
    v_and_b32 v77, 0xffff0000, v58
    v_add_f32 v68, v68, v76
    v_add_f32 v69, v69, v77
    v_lshlrev_b32 v78, 16, v59
    v_and_b32 v79, 0xffff0000, v59
    v_add_f32 v70, v70, v78
    v_add_f32 v71, v71, v79
    v_lshlrev_b32 v72, 16, v60
    v_and_b32 v73, 0xffff0000, v60
    v_add_f32 v64, v64, v72
    v_add_f32 v65, v65, v73
    v_lshlrev_b32 v74, 16, v61
    v_and_b32 v75, 0xffff0000, v61
    v_add_f32 v66, v66, v74
    v_add_f32 v67, v67, v75
    v_lshlrev_b32 v76, 16, v62
    v_and_b32 v77, 0xffff0000, v62
    v_add_f32 v68, v68, v76
    v_add_f32 v69, v69, v77
    v_lshlrev_b32 v78, 16, v63
    v_and_b32 v79, 0xffff0000, v63
    v_add_f32 v70, v70, v78
    v_add_f32 v71, v71, v79
    v_cvt_pk_bf16_f32 v8, v64, v65
    v_cvt_pk_bf16_f32 v9, v66, v67
    v_cvt_pk_bf16_f32 v10, v68, v69
    v_cvt_pk_bf16_f32 v11, v70, v71
    s_add_u32 s58, s90, 0
    buffer_store_dwordx2 v[8:9], v12, s[44:47], s58 offen offset:0
    buffer_store_dwordx2 v[10:11], v12, s[44:47], s58 offen offset:32
    s_waitcnt vmcnt(2)
    v_and_b32 v20, 15, v0
    v_lshrrev_b32 v21, 4, v0
    v_lshlrev_b32 v21, 3, v21
    v_lshl_add_u32 v20, v20, 10, v21
    v_lshlrev_b32 v128, 16, v96
    v_and_b32 v129, 0xffff0000, v96
    v_lshlrev_b32 v130, 16, v97
    v_and_b32 v131, 0xffff0000, v97
    v_lshlrev_b32 v132, 16, v98
    v_and_b32 v133, 0xffff0000, v98
    v_lshlrev_b32 v134, 16, v99
    v_and_b32 v135, 0xffff0000, v99
    v_lshlrev_b32 v136, 16, v100
    v_and_b32 v137, 0xffff0000, v100
    v_add_f32 v128, v128, v136
    v_add_f32 v129, v129, v137
    v_lshlrev_b32 v138, 16, v101
    v_and_b32 v139, 0xffff0000, v101
    v_add_f32 v130, v130, v138
    v_add_f32 v131, v131, v139
    v_lshlrev_b32 v140, 16, v102
    v_and_b32 v141, 0xffff0000, v102
    v_add_f32 v132, v132, v140
    v_add_f32 v133, v133, v141
    v_lshlrev_b32 v142, 16, v103
    v_and_b32 v143, 0xffff0000, v103
    v_add_f32 v134, v134, v142
    v_add_f32 v135, v135, v143
    v_lshlrev_b32 v136, 16, v104
    v_and_b32 v137, 0xffff0000, v104
    v_add_f32 v128, v128, v136
    v_add_f32 v129, v129, v137
    v_lshlrev_b32 v138, 16, v105
    v_and_b32 v139, 0xffff0000, v105
    v_add_f32 v130, v130, v138
    v_add_f32 v131, v131, v139
    v_lshlrev_b32 v140, 16, v106
    v_and_b32 v141, 0xffff0000, v106
    v_add_f32 v132, v132, v140
    v_add_f32 v133, v133, v141
    v_lshlrev_b32 v142, 16, v107
    v_and_b32 v143, 0xffff0000, v107
    v_add_f32 v134, v134, v142
    v_add_f32 v135, v135, v143
    v_lshlrev_b32 v136, 16, v108
    v_and_b32 v137, 0xffff0000, v108
    v_add_f32 v128, v128, v136
    v_add_f32 v129, v129, v137
    v_lshlrev_b32 v138, 16, v109
    v_and_b32 v139, 0xffff0000, v109
    v_add_f32 v130, v130, v138
    v_add_f32 v131, v131, v139
    v_lshlrev_b32 v140, 16, v110
    v_and_b32 v141, 0xffff0000, v110
    v_add_f32 v132, v132, v140
    v_add_f32 v133, v133, v141
    v_lshlrev_b32 v142, 16, v111
    v_and_b32 v143, 0xffff0000, v111
    v_add_f32 v134, v134, v142
    v_add_f32 v135, v135, v143
    v_lshlrev_b32 v136, 16, v112
    v_and_b32 v137, 0xffff0000, v112
    v_add_f32 v128, v128, v136
    v_add_f32 v129, v129, v137
    v_lshlrev_b32 v138, 16, v113
    v_and_b32 v139, 0xffff0000, v113
    v_add_f32 v130, v130, v138
    v_add_f32 v131, v131, v139
    v_lshlrev_b32 v140, 16, v114
    v_and_b32 v141, 0xffff0000, v114
    v_add_f32 v132, v132, v140
    v_add_f32 v133, v133, v141
    v_lshlrev_b32 v142, 16, v115
    v_and_b32 v143, 0xffff0000, v115
    v_add_f32 v134, v134, v142
    v_add_f32 v135, v135, v143
    v_lshlrev_b32 v136, 16, v116
    v_and_b32 v137, 0xffff0000, v116
    v_add_f32 v128, v128, v136
    v_add_f32 v129, v129, v137
    v_lshlrev_b32 v138, 16, v117
    v_and_b32 v139, 0xffff0000, v117
    v_add_f32 v130, v130, v138
    v_add_f32 v131, v131, v139
    v_lshlrev_b32 v140, 16, v118
    v_and_b32 v141, 0xffff0000, v118
    v_add_f32 v132, v132, v140
    v_add_f32 v133, v133, v141
    v_lshlrev_b32 v142, 16, v119
    v_and_b32 v143, 0xffff0000, v119
    v_add_f32 v134, v134, v142
    v_add_f32 v135, v135, v143
    v_lshlrev_b32 v136, 16, v120
    v_and_b32 v137, 0xffff0000, v120
    v_add_f32 v128, v128, v136
    v_add_f32 v129, v129, v137
    v_lshlrev_b32 v138, 16, v121
    v_and_b32 v139, 0xffff0000, v121
    v_add_f32 v130, v130, v138
    v_add_f32 v131, v131, v139
    v_lshlrev_b32 v140, 16, v122
    v_and_b32 v141, 0xffff0000, v122
    v_add_f32 v132, v132, v140
    v_add_f32 v133, v133, v141
    v_lshlrev_b32 v142, 16, v123
    v_and_b32 v143, 0xffff0000, v123
    v_add_f32 v134, v134, v142
    v_add_f32 v135, v135, v143
    v_lshlrev_b32 v136, 16, v124
    v_and_b32 v137, 0xffff0000, v124
    v_add_f32 v128, v128, v136
    v_add_f32 v129, v129, v137
    v_lshlrev_b32 v138, 16, v125
    v_and_b32 v139, 0xffff0000, v125
    v_add_f32 v130, v130, v138
    v_add_f32 v131, v131, v139
    v_lshlrev_b32 v140, 16, v126
    v_and_b32 v141, 0xffff0000, v126
    v_add_f32 v132, v132, v140
    v_add_f32 v133, v133, v141
    v_lshlrev_b32 v142, 16, v127
    v_and_b32 v143, 0xffff0000, v127
    v_add_f32 v134, v134, v142
    v_add_f32 v135, v135, v143
    v_cvt_pk_bf16_f32 v16, v128, v129
    v_cvt_pk_bf16_f32 v17, v130, v131
    v_cvt_pk_bf16_f32 v18, v132, v133
    v_cvt_pk_bf16_f32 v19, v134, v135
    s_add_u32 s58, s90, 786432
    buffer_store_dwordx2 v[16:17], v20, s[44:47], s58 offen offset:0
    buffer_store_dwordx2 v[18:19], v20, s[44:47], s58 offen offset:32
    s_branch L_skip_36
L_slow_37:
    v_cmp_ne_u32 vcc, 1, v207
    s_nop 3
    s_cbranch_vccz L_pd_39
    s_mov_b32 s60, 0x200000
L_p_38:
    v_and_b32 v205, 7, v0
    v_lshlrev_b32 v205, 2, v205
    s_mov_b32 s59, s63
    buffer_load_dword v204, v205, s[40:43], s59 offen sc1
    s_waitcnt vmcnt(0)
    v_cmp_ne_u32 vcc, 1, v204
    s_nop 3
    s_cbranch_vccz L_done_40
    s_sub_u32 s60, s60, 1
    s_cbranch_scc0 L_p_38
L_done_40:
L_pd_39:
    s_add_u32 s58, s89, 0
    buffer_load_dwordx4 v[32:35], v23, s[40:43], s58 offen sc1
    s_add_u32 s58, s89, 24576
    buffer_load_dwordx4 v[36:39], v23, s[40:43], s58 offen sc1
    s_add_u32 s58, s89, 49152
    buffer_load_dwordx4 v[40:43], v23, s[40:43], s58 offen sc1
    s_add_u32 s58, s89, 73728
    buffer_load_dwordx4 v[44:47], v23, s[40:43], s58 offen sc1
    s_add_u32 s58, s89, 98304
    buffer_load_dwordx4 v[48:51], v23, s[40:43], s58 offen sc1
    s_add_u32 s58, s89, 122880
    buffer_load_dwordx4 v[52:55], v23, s[40:43], s58 offen sc1
    s_add_u32 s58, s89, 147456
    buffer_load_dwordx4 v[56:59], v23, s[40:43], s58 offen sc1
    s_add_u32 s58, s89, 172032
    buffer_load_dwordx4 v[60:63], v23, s[40:43], s58 offen sc1
    v_and_b32 v205, 7, v0
    v_lshlrev_b32 v205, 2, v205
    s_add_u32 s59, s63, 4096
    buffer_load_dword v207, v205, s[40:43], s59 offen sc1
    s_waitcnt vmcnt(1)
    v_and_b32 v12, 15, v0
    v_lshrrev_b32 v13, 4, v0
    v_lshlrev_b32 v13, 3, v13
    v_lshl_add_u32 v12, v12, 10, v13
    v_lshlrev_b32 v64, 16, v32
    v_and_b32 v65, 0xffff0000, v32
    v_lshlrev_b32 v66, 16, v33
    v_and_b32 v67, 0xffff0000, v33
    v_lshlrev_b32 v68, 16, v34
    v_and_b32 v69, 0xffff0000, v34
    v_lshlrev_b32 v70, 16, v35
    v_and_b32 v71, 0xffff0000, v35
    v_lshlrev_b32 v72, 16, v36
    v_and_b32 v73, 0xffff0000, v36
    v_add_f32 v64, v64, v72
    v_add_f32 v65, v65, v73
    v_lshlrev_b32 v74, 16, v37
    v_and_b32 v75, 0xffff0000, v37
    v_add_f32 v66, v66, v74
    v_add_f32 v67, v67, v75
    v_lshlrev_b32 v76, 16, v38
    v_and_b32 v77, 0xffff0000, v38
    v_add_f32 v68, v68, v76
    v_add_f32 v69, v69, v77
    v_lshlrev_b32 v78, 16, v39
    v_and_b32 v79, 0xffff0000, v39
    v_add_f32 v70, v70, v78
    v_add_f32 v71, v71, v79
    v_lshlrev_b32 v72, 16, v40
    v_and_b32 v73, 0xffff0000, v40
    v_add_f32 v64, v64, v72
    v_add_f32 v65, v65, v73
    v_lshlrev_b32 v74, 16, v41
    v_and_b32 v75, 0xffff0000, v41
    v_add_f32 v66, v66, v74
    v_add_f32 v67, v67, v75
    v_lshlrev_b32 v76, 16, v42
    v_and_b32 v77, 0xffff0000, v42
    v_add_f32 v68, v68, v76
    v_add_f32 v69, v69, v77
    v_lshlrev_b32 v78, 16, v43
    v_and_b32 v79, 0xffff0000, v43
    v_add_f32 v70, v70, v78
    v_add_f32 v71, v71, v79
    v_lshlrev_b32 v72, 16, v44
    v_and_b32 v73, 0xffff0000, v44
    v_add_f32 v64, v64, v72
    v_add_f32 v65, v65, v73
    v_lshlrev_b32 v74, 16, v45
    v_and_b32 v75, 0xffff0000, v45
    v_add_f32 v66, v66, v74
    v_add_f32 v67, v67, v75
    v_lshlrev_b32 v76, 16, v46
    v_and_b32 v77, 0xffff0000, v46
    v_add_f32 v68, v68, v76
    v_add_f32 v69, v69, v77
    v_lshlrev_b32 v78, 16, v47
    v_and_b32 v79, 0xffff0000, v47
    v_add_f32 v70, v70, v78
    v_add_f32 v71, v71, v79
    v_lshlrev_b32 v72, 16, v48
    v_and_b32 v73, 0xffff0000, v48
    v_add_f32 v64, v64, v72
    v_add_f32 v65, v65, v73
    v_lshlrev_b32 v74, 16, v49
    v_and_b32 v75, 0xffff0000, v49
    v_add_f32 v66, v66, v74
    v_add_f32 v67, v67, v75
    v_lshlrev_b32 v76, 16, v50
    v_and_b32 v77, 0xffff0000, v50
    v_add_f32 v68, v68, v76
    v_add_f32 v69, v69, v77
    v_lshlrev_b32 v78, 16, v51
    v_and_b32 v79, 0xffff0000, v51
    v_add_f32 v70, v70, v78
    v_add_f32 v71, v71, v79
    v_lshlrev_b32 v72, 16, v52
    v_and_b32 v73, 0xffff0000, v52
    v_add_f32 v64, v64, v72
    v_add_f32 v65, v65, v73
    v_lshlrev_b32 v74, 16, v53
    v_and_b32 v75, 0xffff0000, v53
    v_add_f32 v66, v66, v74
    v_add_f32 v67, v67, v75
    v_lshlrev_b32 v76, 16, v54
    v_and_b32 v77, 0xffff0000, v54
    v_add_f32 v68, v68, v76
    v_add_f32 v69, v69, v77
    v_lshlrev_b32 v78, 16, v55
    v_and_b32 v79, 0xffff0000, v55
    v_add_f32 v70, v70, v78
    v_add_f32 v71, v71, v79
    v_lshlrev_b32 v72, 16, v56
    v_and_b32 v73, 0xffff0000, v56
    v_add_f32 v64, v64, v72
    v_add_f32 v65, v65, v73
    v_lshlrev_b32 v74, 16, v57
    v_and_b32 v75, 0xffff0000, v57
    v_add_f32 v66, v66, v74
    v_add_f32 v67, v67, v75
    v_lshlrev_b32 v76, 16, v58
    v_and_b32 v77, 0xffff0000, v58
    v_add_f32 v68, v68, v76
    v_add_f32 v69, v69, v77
    v_lshlrev_b32 v78, 16, v59
    v_and_b32 v79, 0xffff0000, v59
    v_add_f32 v70, v70, v78
    v_add_f32 v71, v71, v79
    v_lshlrev_b32 v72, 16, v60
    v_and_b32 v73, 0xffff0000, v60
    v_add_f32 v64, v64, v72
    v_add_f32 v65, v65, v73
    v_lshlrev_b32 v74, 16, v61
    v_and_b32 v75, 0xffff0000, v61
    v_add_f32 v66, v66, v74
    v_add_f32 v67, v67, v75
    v_lshlrev_b32 v76, 16, v62
    v_and_b32 v77, 0xffff0000, v62
    v_add_f32 v68, v68, v76
    v_add_f32 v69, v69, v77
    v_lshlrev_b32 v78, 16, v63
    v_and_b32 v79, 0xffff0000, v63
    v_add_f32 v70, v70, v78
    v_add_f32 v71, v71, v79
    v_cvt_pk_bf16_f32 v8, v64, v65
    v_cvt_pk_bf16_f32 v9, v66, v67
    v_cvt_pk_bf16_f32 v10, v68, v69
    v_cvt_pk_bf16_f32 v11, v70, v71
    s_add_u32 s58, s90, 0
    buffer_store_dwordx2 v[8:9], v12, s[44:47], s58 offen offset:0
    buffer_store_dwordx2 v[10:11], v12, s[44:47], s58 offen offset:32
    s_waitcnt vmcnt(2)
    v_cmp_ne_u32 vcc, 1, v207
    s_nop 3
    s_cbranch_vccz L_pd_42
    s_mov_b32 s60, 0x200000
L_p_41:
    v_and_b32 v205, 7, v0
    v_lshlrev_b32 v205, 2, v205
    s_add_u32 s59, s63, 4096
    buffer_load_dword v204, v205, s[40:43], s59 offen sc1
    s_waitcnt vmcnt(0)
    v_cmp_ne_u32 vcc, 1, v204
    s_nop 3
    s_cbranch_vccz L_done_43
    s_sub_u32 s60, s60, 1
    s_cbranch_scc0 L_p_41
L_done_43:
L_pd_42:
    s_add_u32 s58, s89, 6291456
    buffer_load_dwordx4 v[96:99], v23, s[40:43], s58 offen sc1
    s_add_u32 s58, s89, 6316032
    buffer_load_dwordx4 v[100:103], v23, s[40:43], s58 offen sc1
    s_add_u32 s58, s89, 6340608
    buffer_load_dwordx4 v[104:107], v23, s[40:43], s58 offen sc1
    s_add_u32 s58, s89, 6365184
    buffer_load_dwordx4 v[108:111], v23, s[40:43], s58 offen sc1
    s_add_u32 s58, s89, 6389760
    buffer_load_dwordx4 v[112:115], v23, s[40:43], s58 offen sc1
    s_add_u32 s58, s89, 6414336
    buffer_load_dwordx4 v[116:119], v23, s[40:43], s58 offen sc1
    s_add_u32 s58, s89, 6438912
    buffer_load_dwordx4 v[120:123], v23, s[40:43], s58 offen sc1
    s_add_u32 s58, s89, 6463488
    buffer_load_dwordx4 v[124:127], v23, s[40:43], s58 offen sc1
    s_waitcnt vmcnt(0)
    v_and_b32 v20, 15, v0
    v_lshrrev_b32 v21, 4, v0
    v_lshlrev_b32 v21, 3, v21
    v_lshl_add_u32 v20, v20, 10, v21
    v_lshlrev_b32 v128, 16, v96
    v_and_b32 v129, 0xffff0000, v96
    v_lshlrev_b32 v130, 16, v97
    v_and_b32 v131, 0xffff0000, v97
    v_lshlrev_b32 v132, 16, v98
    v_and_b32 v133, 0xffff0000, v98
    v_lshlrev_b32 v134, 16, v99
    v_and_b32 v135, 0xffff0000, v99
    v_lshlrev_b32 v136, 16, v100
    v_and_b32 v137, 0xffff0000, v100
    v_add_f32 v128, v128, v136
    v_add_f32 v129, v129, v137
    v_lshlrev_b32 v138, 16, v101
    v_and_b32 v139, 0xffff0000, v101
    v_add_f32 v130, v130, v138
    v_add_f32 v131, v131, v139
    v_lshlrev_b32 v140, 16, v102
    v_and_b32 v141, 0xffff0000, v102
    v_add_f32 v132, v132, v140
    v_add_f32 v133, v133, v141
    v_lshlrev_b32 v142, 16, v103
    v_and_b32 v143, 0xffff0000, v103
    v_add_f32 v134, v134, v142
    v_add_f32 v135, v135, v143
    v_lshlrev_b32 v136, 16, v104
    v_and_b32 v137, 0xffff0000, v104
    v_add_f32 v128, v128, v136
    v_add_f32 v129, v129, v137
    v_lshlrev_b32 v138, 16, v105
    v_and_b32 v139, 0xffff0000, v105
    v_add_f32 v130, v130, v138
    v_add_f32 v131, v131, v139
    v_lshlrev_b32 v140, 16, v106
    v_and_b32 v141, 0xffff0000, v106
    v_add_f32 v132, v132, v140
    v_add_f32 v133, v133, v141
    v_lshlrev_b32 v142, 16, v107
    v_and_b32 v143, 0xffff0000, v107
    v_add_f32 v134, v134, v142
    v_add_f32 v135, v135, v143
    v_lshlrev_b32 v136, 16, v108
    v_and_b32 v137, 0xffff0000, v108
    v_add_f32 v128, v128, v136
    v_add_f32 v129, v129, v137
    v_lshlrev_b32 v138, 16, v109
    v_and_b32 v139, 0xffff0000, v109
    v_add_f32 v130, v130, v138
    v_add_f32 v131, v131, v139
    v_lshlrev_b32 v140, 16, v110
    v_and_b32 v141, 0xffff0000, v110
    v_add_f32 v132, v132, v140
    v_add_f32 v133, v133, v141
    v_lshlrev_b32 v142, 16, v111
    v_and_b32 v143, 0xffff0000, v111
    v_add_f32 v134, v134, v142
    v_add_f32 v135, v135, v143
    v_lshlrev_b32 v136, 16, v112
    v_and_b32 v137, 0xffff0000, v112
    v_add_f32 v128, v128, v136
    v_add_f32 v129, v129, v137
    v_lshlrev_b32 v138, 16, v113
    v_and_b32 v139, 0xffff0000, v113
    v_add_f32 v130, v130, v138
    v_add_f32 v131, v131, v139
    v_lshlrev_b32 v140, 16, v114
    v_and_b32 v141, 0xffff0000, v114
    v_add_f32 v132, v132, v140
    v_add_f32 v133, v133, v141
    v_lshlrev_b32 v142, 16, v115
    v_and_b32 v143, 0xffff0000, v115
    v_add_f32 v134, v134, v142
    v_add_f32 v135, v135, v143
    v_lshlrev_b32 v136, 16, v116
    v_and_b32 v137, 0xffff0000, v116
    v_add_f32 v128, v128, v136
    v_add_f32 v129, v129, v137
    v_lshlrev_b32 v138, 16, v117
    v_and_b32 v139, 0xffff0000, v117
    v_add_f32 v130, v130, v138
    v_add_f32 v131, v131, v139
    v_lshlrev_b32 v140, 16, v118
    v_and_b32 v141, 0xffff0000, v118
    v_add_f32 v132, v132, v140
    v_add_f32 v133, v133, v141
    v_lshlrev_b32 v142, 16, v119
    v_and_b32 v143, 0xffff0000, v119
    v_add_f32 v134, v134, v142
    v_add_f32 v135, v135, v143
    v_lshlrev_b32 v136, 16, v120
    v_and_b32 v137, 0xffff0000, v120
    v_add_f32 v128, v128, v136
    v_add_f32 v129, v129, v137
    v_lshlrev_b32 v138, 16, v121
    v_and_b32 v139, 0xffff0000, v121
    v_add_f32 v130, v130, v138
    v_add_f32 v131, v131, v139
    v_lshlrev_b32 v140, 16, v122
    v_and_b32 v141, 0xffff0000, v122
    v_add_f32 v132, v132, v140
    v_add_f32 v133, v133, v141
    v_lshlrev_b32 v142, 16, v123
    v_and_b32 v143, 0xffff0000, v123
    v_add_f32 v134, v134, v142
    v_add_f32 v135, v135, v143
    v_lshlrev_b32 v136, 16, v124
    v_and_b32 v137, 0xffff0000, v124
    v_add_f32 v128, v128, v136
    v_add_f32 v129, v129, v137
    v_lshlrev_b32 v138, 16, v125
    v_and_b32 v139, 0xffff0000, v125
    v_add_f32 v130, v130, v138
    v_add_f32 v131, v131, v139
    v_lshlrev_b32 v140, 16, v126
    v_and_b32 v141, 0xffff0000, v126
    v_add_f32 v132, v132, v140
    v_add_f32 v133, v133, v141
    v_lshlrev_b32 v142, 16, v127
    v_and_b32 v143, 0xffff0000, v127
    v_add_f32 v134, v134, v142
    v_add_f32 v135, v135, v143
    v_cvt_pk_bf16_f32 v16, v128, v129
    v_cvt_pk_bf16_f32 v17, v130, v131
    v_cvt_pk_bf16_f32 v18, v132, v133
    v_cvt_pk_bf16_f32 v19, v134, v135
    s_add_u32 s58, s90, 786432
    buffer_store_dwordx2 v[16:17], v20, s[44:47], s58 offen offset:0
    buffer_store_dwordx2 v[18:19], v20, s[44:47], s58 offen offset:32
L_skip_36:
L_end:
    s_endpgm
L_rare_8:
    v_mov_b32 v193, v192
    s_nop 1
    v_permlane16_swap_b32 v192, v193
    v_max_f32 v192, v192, v193
    v_mov_b32 v193, v192
    s_nop 1
    v_permlane32_swap_b32 v192, v193
    v_max_f32 v192, v192, v193
    v_max_f32 v192, 0, v192
    v_sub_f32 v56, v56, v192
    v_sub_f32 v57, v57, v192
    v_sub_f32 v58, v58, v192
    v_sub_f32 v59, v59, v192
    v_sub_f32 v32, v32, v192
    v_sub_f32 v33, v33, v192
    v_sub_f32 v34, v34, v192
    v_sub_f32 v35, v35, v192
    v_sub_f32 v44, v44, v192
    v_sub_f32 v45, v45, v192
    v_sub_f32 v46, v46, v192
    v_sub_f32 v47, v47, v192
    v_sub_f32 v193, 0, v192
    v_exp_f32 v193, v193
    s_nop 0
    v_mul_f32 v80, v80, v193
    v_mul_f32 v81, v81, v193
    v_mul_f32 v82, v82, v193
    v_mul_f32 v83, v83, v193
    v_mul_f32 v92, v92, v193
    v_mul_f32 v93, v93, v193
    v_mul_f32 v94, v94, v193
    v_mul_f32 v95, v95, v193
    v_mul_f32 v104, v104, v193
    v_mul_f32 v105, v105, v193
    v_mul_f32 v106, v106, v193
    v_mul_f32 v107, v107, v193
    v_mul_f32 v116, v116, v193
    v_mul_f32 v117, v117, v193
    v_mul_f32 v118, v118, v193
    v_mul_f32 v119, v119, v193
    v_mul_f32 v128, v128, v193
    v_mul_f32 v129, v129, v193
    v_mul_f32 v130, v130, v193
    v_mul_f32 v131, v131, v193
    v_mul_f32 v140, v140, v193
    v_mul_f32 v141, v141, v193
    v_mul_f32 v142, v142, v193
    v_mul_f32 v143, v143, v193
    v_mul_f32 v152, v152, v193
    v_mul_f32 v153, v153, v193
    v_mul_f32 v154, v154, v193
    v_mul_f32 v155, v155, v193
    v_mul_f32 v164, v164, v193
    v_mul_f32 v165, v165, v193
    v_mul_f32 v166, v166, v193
    v_mul_f32 v167, v167, v193
    v_mul_f32 v176, v176, v193
    v_mul_f32 v177, v177, v193
    v_mul_f32 v178, v178, v193
    v_mul_f32 v179, v179, v193
    s_branch L_back_9
L_rare_10:
    v_mov_b32 v195, v194
    s_nop 1
    v_permlane16_swap_b32 v194, v195
    v_max_f32 v194, v194, v195
    v_mov_b32 v195, v194
    s_nop 1
    v_permlane32_swap_b32 v194, v195
    v_max_f32 v194, v194, v195
    v_max_f32 v194, 0, v194
    v_sub_f32 v60, v60, v194
    v_sub_f32 v61, v61, v194
    v_sub_f32 v62, v62, v194
    v_sub_f32 v63, v63, v194
    v_sub_f32 v36, v36, v194
    v_sub_f32 v37, v37, v194
    v_sub_f32 v38, v38, v194
    v_sub_f32 v39, v39, v194
    v_sub_f32 v48, v48, v194
    v_sub_f32 v49, v49, v194
    v_sub_f32 v50, v50, v194
    v_sub_f32 v51, v51, v194
    v_sub_f32 v195, 0, v194
    v_exp_f32 v195, v195
    s_nop 0
    v_mul_f32 v84, v84, v195
    v_mul_f32 v85, v85, v195
    v_mul_f32 v86, v86, v195
    v_mul_f32 v87, v87, v195
    v_mul_f32 v96, v96, v195
    v_mul_f32 v97, v97, v195
    v_mul_f32 v98, v98, v195
    v_mul_f32 v99, v99, v195
    v_mul_f32 v108, v108, v195
    v_mul_f32 v109, v109, v195
    v_mul_f32 v110, v110, v195
    v_mul_f32 v111, v111, v195
    v_mul_f32 v120, v120, v195
    v_mul_f32 v121, v121, v195
    v_mul_f32 v122, v122, v195
    v_mul_f32 v123, v123, v195
    v_mul_f32 v132, v132, v195
    v_mul_f32 v133, v133, v195
    v_mul_f32 v134, v134, v195
    v_mul_f32 v135, v135, v195
    v_mul_f32 v144, v144, v195
    v_mul_f32 v145, v145, v195
    v_mul_f32 v146, v146, v195
    v_mul_f32 v147, v147, v195
    v_mul_f32 v156, v156, v195
    v_mul_f32 v157, v157, v195
    v_mul_f32 v158, v158, v195
    v_mul_f32 v159, v159, v195
    v_mul_f32 v168, v168, v195
    v_mul_f32 v169, v169, v195
    v_mul_f32 v170, v170, v195
    v_mul_f32 v171, v171, v195
    v_mul_f32 v180, v180, v195
    v_mul_f32 v181, v181, v195
    v_mul_f32 v182, v182, v195
    v_mul_f32 v183, v183, v195
    s_branch L_back_11
L_rare_12:
    v_mov_b32 v197, v196
    s_nop 1
    v_permlane16_swap_b32 v196, v197
    v_max_f32 v196, v196, v197
    v_mov_b32 v197, v196
    s_nop 1
    v_permlane32_swap_b32 v196, v197
    v_max_f32 v196, v196, v197
    v_max_f32 v196, 0, v196
    v_sub_f32 v64, v64, v196
    v_sub_f32 v65, v65, v196
    v_sub_f32 v66, v66, v196
    v_sub_f32 v67, v67, v196
    v_sub_f32 v40, v40, v196
    v_sub_f32 v41, v41, v196
    v_sub_f32 v42, v42, v196
    v_sub_f32 v43, v43, v196
    v_sub_f32 v52, v52, v196
    v_sub_f32 v53, v53, v196
    v_sub_f32 v54, v54, v196
    v_sub_f32 v55, v55, v196
    v_sub_f32 v197, 0, v196
    v_exp_f32 v197, v197
    s_nop 0
    v_mul_f32 v88, v88, v197
    v_mul_f32 v89, v89, v197
    v_mul_f32 v90, v90, v197
    v_mul_f32 v91, v91, v197
    v_mul_f32 v100, v100, v197
    v_mul_f32 v101, v101, v197
    v_mul_f32 v102, v102, v197
    v_mul_f32 v103, v103, v197
    v_mul_f32 v112, v112, v197
    v_mul_f32 v113, v113, v197
    v_mul_f32 v114, v114, v197
    v_mul_f32 v115, v115, v197
    v_mul_f32 v124, v124, v197
    v_mul_f32 v125, v125, v197
    v_mul_f32 v126, v126, v197
    v_mul_f32 v127, v127, v197
    v_mul_f32 v136, v136, v197
    v_mul_f32 v137, v137, v197
    v_mul_f32 v138, v138, v197
    v_mul_f32 v139, v139, v197
    v_mul_f32 v148, v148, v197
    v_mul_f32 v149, v149, v197
    v_mul_f32 v150, v150, v197
    v_mul_f32 v151, v151, v197
    v_mul_f32 v160, v160, v197
    v_mul_f32 v161, v161, v197
    v_mul_f32 v162, v162, v197
    v_mul_f32 v163, v163, v197
    v_mul_f32 v172, v172, v197
    v_mul_f32 v173, v173, v197
    v_mul_f32 v174, v174, v197
    v_mul_f32 v175, v175, v197
    v_mul_f32 v184, v184, v197
    v_mul_f32 v185, v185, v197
    v_mul_f32 v186, v186, v197
    v_mul_f32 v187, v187, v197
    s_branch L_back_13
L_rare_19:
    v_mov_b32 v193, v192
    s_nop 1
    v_permlane16_swap_b32 v192, v193
    v_max_f32 v192, v192, v193
    v_mov_b32 v193, v192
    s_nop 1
    v_permlane32_swap_b32 v192, v193
    v_max_f32 v192, v192, v193
    v_max_f32 v192, 0, v192
    v_sub_f32 v56, v56, v192
    v_sub_f32 v57, v57, v192
    v_sub_f32 v58, v58, v192
    v_sub_f32 v59, v59, v192
    v_sub_f32 v32, v32, v192
    v_sub_f32 v33, v33, v192
    v_sub_f32 v34, v34, v192
    v_sub_f32 v35, v35, v192
    v_sub_f32 v44, v44, v192
    v_sub_f32 v45, v45, v192
    v_sub_f32 v46, v46, v192
    v_sub_f32 v47, v47, v192
    v_sub_f32 v193, 0, v192
    v_exp_f32 v193, v193
    s_nop 0
    v_mul_f32 v80, v80, v193
    v_mul_f32 v81, v81, v193
    v_mul_f32 v82, v82, v193
    v_mul_f32 v83, v83, v193
    v_mul_f32 v92, v92, v193
    v_mul_f32 v93, v93, v193
    v_mul_f32 v94, v94, v193
    v_mul_f32 v95, v95, v193
    v_mul_f32 v104, v104, v193
    v_mul_f32 v105, v105, v193
    v_mul_f32 v106, v106, v193
    v_mul_f32 v107, v107, v193
    v_mul_f32 v116, v116, v193
    v_mul_f32 v117, v117, v193
    v_mul_f32 v118, v118, v193
    v_mul_f32 v119, v119, v193
    v_mul_f32 v128, v128, v193
    v_mul_f32 v129, v129, v193
    v_mul_f32 v130, v130, v193
    v_mul_f32 v131, v131, v193
    v_mul_f32 v140, v140, v193
    v_mul_f32 v141, v141, v193
    v_mul_f32 v142, v142, v193
    v_mul_f32 v143, v143, v193
    v_mul_f32 v152, v152, v193
    v_mul_f32 v153, v153, v193
    v_mul_f32 v154, v154, v193
    v_mul_f32 v155, v155, v193
    v_mul_f32 v164, v164, v193
    v_mul_f32 v165, v165, v193
    v_mul_f32 v166, v166, v193
    v_mul_f32 v167, v167, v193
    v_mul_f32 v176, v176, v193
    v_mul_f32 v177, v177, v193
    v_mul_f32 v178, v178, v193
    v_mul_f32 v179, v179, v193
    s_branch L_back_20
L_rare_21:
    v_mov_b32 v195, v194
    s_nop 1
    v_permlane16_swap_b32 v194, v195
    v_max_f32 v194, v194, v195
    v_mov_b32 v195, v194
    s_nop 1
    v_permlane32_swap_b32 v194, v195
    v_max_f32 v194, v194, v195
    v_max_f32 v194, 0, v194
    v_sub_f32 v60, v60, v194
    v_sub_f32 v61, v61, v194
    v_sub_f32 v62, v62, v194
    v_sub_f32 v63, v63, v194
    v_sub_f32 v36, v36, v194
    v_sub_f32 v37, v37, v194
    v_sub_f32 v38, v38, v194
    v_sub_f32 v39, v39, v194
    v_sub_f32 v48, v48, v194
    v_sub_f32 v49, v49, v194
    v_sub_f32 v50, v50, v194
    v_sub_f32 v51, v51, v194
    v_sub_f32 v195, 0, v194
    v_exp_f32 v195, v195
    s_nop 0
    v_mul_f32 v84, v84, v195
    v_mul_f32 v85, v85, v195
    v_mul_f32 v86, v86, v195
    v_mul_f32 v87, v87, v195
    v_mul_f32 v96, v96, v195
    v_mul_f32 v97, v97, v195
    v_mul_f32 v98, v98, v195
    v_mul_f32 v99, v99, v195
    v_mul_f32 v108, v108, v195
    v_mul_f32 v109, v109, v195
    v_mul_f32 v110, v110, v195
    v_mul_f32 v111, v111, v195
    v_mul_f32 v120, v120, v195
    v_mul_f32 v121, v121, v195
    v_mul_f32 v122, v122, v195
    v_mul_f32 v123, v123, v195
    v_mul_f32 v132, v132, v195
    v_mul_f32 v133, v133, v195
    v_mul_f32 v134, v134, v195
    v_mul_f32 v135, v135, v195
    v_mul_f32 v144, v144, v195
    v_mul_f32 v145, v145, v195
    v_mul_f32 v146, v146, v195
    v_mul_f32 v147, v147, v195
    v_mul_f32 v156, v156, v195
    v_mul_f32 v157, v157, v195
    v_mul_f32 v158, v158, v195
    v_mul_f32 v159, v159, v195
    v_mul_f32 v168, v168, v195
    v_mul_f32 v169, v169, v195
    v_mul_f32 v170, v170, v195
    v_mul_f32 v171, v171, v195
    v_mul_f32 v180, v180, v195
    v_mul_f32 v181, v181, v195
    v_mul_f32 v182, v182, v195
    v_mul_f32 v183, v183, v195
    s_branch L_back_22
L_rare_23:
    v_mov_b32 v197, v196
    s_nop 1
    v_permlane16_swap_b32 v196, v197
    v_max_f32 v196, v196, v197
    v_mov_b32 v197, v196
    s_nop 1
    v_permlane32_swap_b32 v196, v197
    v_max_f32 v196, v196, v197
    v_max_f32 v196, 0, v196
    v_sub_f32 v64, v64, v196
    v_sub_f32 v65, v65, v196
    v_sub_f32 v66, v66, v196
    v_sub_f32 v67, v67, v196
    v_sub_f32 v40, v40, v196
    v_sub_f32 v41, v41, v196
    v_sub_f32 v42, v42, v196
    v_sub_f32 v43, v43, v196
    v_sub_f32 v52, v52, v196
    v_sub_f32 v53, v53, v196
    v_sub_f32 v54, v54, v196
    v_sub_f32 v55, v55, v196
    v_sub_f32 v197, 0, v196
    v_exp_f32 v197, v197
    s_nop 0
    v_mul_f32 v88, v88, v197
    v_mul_f32 v89, v89, v197
    v_mul_f32 v90, v90, v197
    v_mul_f32 v91, v91, v197
    v_mul_f32 v100, v100, v197
    v_mul_f32 v101, v101, v197
    v_mul_f32 v102, v102, v197
    v_mul_f32 v103, v103, v197
    v_mul_f32 v112, v112, v197
    v_mul_f32 v113, v113, v197
    v_mul_f32 v114, v114, v197
    v_mul_f32 v115, v115, v197
    v_mul_f32 v124, v124, v197
    v_mul_f32 v125, v125, v197
    v_mul_f32 v126, v126, v197
    v_mul_f32 v127, v127, v197
    v_mul_f32 v136, v136, v197
    v_mul_f32 v137, v137, v197
    v_mul_f32 v138, v138, v197
    v_mul_f32 v139, v139, v197
    v_mul_f32 v148, v148, v197
    v_mul_f32 v149, v149, v197
    v_mul_f32 v150, v150, v197
    v_mul_f32 v151, v151, v197
    v_mul_f32 v160, v160, v197
    v_mul_f32 v161, v161, v197
    v_mul_f32 v162, v162, v197
    v_mul_f32 v163, v163, v197
    v_mul_f32 v172, v172, v197
    v_mul_f32 v173, v173, v197
    v_mul_f32 v174, v174, v197
    v_mul_f32 v175, v175, v197
    v_mul_f32 v184, v184, v197
    v_mul_f32 v185, v185, v197
    v_mul_f32 v186, v186, v197
    v_mul_f32 v187, v187, v197
    s_branch L_back_24
L_fd_4:
    s_cmp_lg_u32 s53, 11
    s_cbranch_scc1 L_hn_44
    s_cmp_lg_u32 s48, 0
    s_cbranch_scc1 L_w0_45
    v_cmp_ne_u32 vcc, 1, v201
    s_nop 3
    s_cbranch_vccz L_w0_45
    s_waitcnt vmcnt(0)
L_w0_45:
    s_branch L_fb_5
L_hn_44:
    s_cmp_lg_u32 s53, 10
    s_cbranch_scc1 L_hn_46
    s_cmp_lg_u32 s48, 0
    s_cbranch_scc1 L_w0_47
    v_cmp_ne_u32 vcc, 1, v201
    s_nop 3
    s_cbranch_vccz L_w0_47
    s_waitcnt vmcnt(0)
L_w0_47:
    s_branch L_fb_5
L_hn_46:
    s_cmp_lg_u32 s53, 9
    s_cbranch_scc1 L_hn_48
    s_cmp_lg_u32 s48, 0
    s_cbranch_scc1 L_w0_49
    v_cmp_ne_u32 vcc, 1, v201
    s_nop 3
    s_cbranch_vccz L_pd_51
    s_mov_b32 s60, 0x200000
L_p_50:
    v_and_b32 v200, 7, v0
    buffer_load_ubyte v201, v200, s[96:99], 0 offen offset:128 sc1
    s_waitcnt vmcnt(0)
    v_cmp_ne_u32 vcc, 1, v201
    s_nop 3
    s_cbranch_vccz L_done_52
    s_sub_u32 s60, s60, 1
    s_cbranch_scc0 L_p_50
L_done_52:
L_pd_51:
L_w0_49:
    s_branch L_fb_5
L_hn_48:
    s_cmp_lg_u32 s53, 5
    s_cbranch_scc1 L_hn_53
    s_cmp_lg_u32 s48, 0
    s_cbranch_scc1 L_w0_54
    v_cmp_ne_u32 vcc, 1, v201
    s_nop 3
    s_cbranch_vccz L_w0_54
    s_waitcnt vmcnt(0)
L_w0_54:
    s_branch L_fb_5
L_hn_53:
    s_cmp_lg_u32 s53, 4
    s_cbranch_scc1 L_hn_55
    s_cmp_lg_u32 s48, 0
    s_cbranch_scc1 L_w0_56
    v_cmp_ne_u32 vcc, 1, v201
    s_nop 3
    s_cbranch_vccz L_w0_56
    s_waitcnt vmcnt(0)
L_w0_56:
    s_branch L_fb_5
L_hn_55:
    s_cmp_lg_u32 s53, 3
    s_cbranch_scc1 L_hn_57
    s_cmp_lg_u32 s48, 0
    s_cbranch_scc1 L_w0_58
    v_cmp_ne_u32 vcc, 1, v201
    s_nop 3
    s_cbranch_vccz L_pd_60
    s_mov_b32 s60, 0x200000
L_p_59:
    v_and_b32 v200, 7, v0
    buffer_load_ubyte v201, v200, s[96:99], 0 offen offset:136 sc1
    s_waitcnt vmcnt(0)
    v_cmp_ne_u32 vcc, 1, v201
    s_nop 3
    s_cbranch_vccz L_done_61
    s_sub_u32 s60, s60, 1
    s_cbranch_scc0 L_p_59
L_done_61:
L_pd_60:
L_w0_58:
    s_branch L_fb_5
L_hn_57:
    s_branch L_fb_5
L_fd_6:
    s_cmp_lg_u32 s53, 13
    s_cbranch_scc1 L_hn_62
    s_cmp_eq_u32 s94, 0
    s_cbranch_scc1 L_fp_63
    v_mov_b32 v204, 1
    v_mov_b32 v205, 0
    s_mov_b64 exec, 1
    buffer_store_byte v204, v205, s[96:99], s2 offen offset:128 sc1
    s_mov_b64 exec, -1
L_fp_63:
    s_branch L_fb_7
L_hn_62:
    s_cmp_lg_u32 s53, 12
    s_cbranch_scc1 L_hn_64
    s_cmp_lg_u32 s48, 0
    s_cbranch_scc1 L_w0_65
    v_and_b32 v200, 7, v0
    buffer_load_ubyte v201, v200, s[96:99], 0 offen offset:128 sc1
L_w0_65:
    s_branch L_fb_7
L_hn_64:
    s_cmp_lg_u32 s53, 11
    s_cbranch_scc1 L_hn_66
    s_cmp_lg_u32 s48, 0
    s_cbranch_scc1 L_w0_67
    v_and_b32 v200, 7, v0
    buffer_load_ubyte v201, v200, s[96:99], 0 offen offset:128 sc1
L_w0_67:
    s_branch L_fb_7
L_hn_66:
    s_cmp_lg_u32 s53, 10
    s_cbranch_scc1 L_hn_68
    s_cmp_lg_u32 s48, 0
    s_cbranch_scc1 L_w0_69
    v_and_b32 v200, 7, v0
    buffer_load_ubyte v201, v200, s[96:99], 0 offen offset:128 sc1
L_w0_69:
    s_branch L_fb_7
L_hn_68:
    s_cmp_lg_u32 s53, 7
    s_cbranch_scc1 L_hn_70
    s_cmp_eq_u32 s94, 0
    s_cbranch_scc1 L_fp_71
    v_mov_b32 v204, 1
    v_mov_b32 v205, 0
    s_mov_b64 exec, 1
    buffer_store_byte v204, v205, s[96:99], s2 offen offset:136 sc1
    s_mov_b64 exec, -1
L_fp_71:
    s_branch L_fb_7
L_hn_70:
    s_cmp_lg_u32 s53, 6
    s_cbranch_scc1 L_hn_72
    s_cmp_lg_u32 s48, 0
    s_cbranch_scc1 L_w0_73
    v_and_b32 v200, 7, v0
    buffer_load_ubyte v201, v200, s[96:99], 0 offen offset:136 sc1
L_w0_73:
    s_branch L_fb_7
L_hn_72:
    s_cmp_lg_u32 s53, 5
    s_cbranch_scc1 L_hn_74
    s_cmp_lg_u32 s48, 0
    s_cbranch_scc1 L_w0_75
    v_and_b32 v200, 7, v0
    buffer_load_ubyte v201, v200, s[96:99], 0 offen offset:136 sc1
L_w0_75:
    s_branch L_fb_7
L_hn_74:
    s_cmp_lg_u32 s53, 4
    s_cbranch_scc1 L_hn_76
    s_cmp_lg_u32 s48, 0
    s_cbranch_scc1 L_w0_77
    v_and_b32 v200, 7, v0
    buffer_load_ubyte v201, v200, s[96:99], 0 offen offset:136 sc1
L_w0_77:
    s_branch L_fb_7
L_hn_76:
    s_branch L_fb_7
L_fd_15:
    s_cmp_lg_u32 s53, 11
    s_cbranch_scc1 L_hn_78
    s_cmp_lg_u32 s48, 0
    s_cbranch_scc1 L_w0_79
    v_cmp_ne_u32 vcc, 1, v201
    s_nop 3
    s_cbranch_vccz L_w0_79
    s_waitcnt vmcnt(0)
L_w0_79:
    s_branch L_fb_16
L_hn_78:
    s_cmp_lg_u32 s53, 10
    s_cbranch_scc1 L_hn_80
    s_cmp_lg_u32 s48, 0
    s_cbranch_scc1 L_w0_81
    v_cmp_ne_u32 vcc, 1, v201
    s_nop 3
    s_cbranch_vccz L_w0_81
    s_waitcnt vmcnt(0)
L_w0_81:
    s_branch L_fb_16
L_hn_80:
    s_cmp_lg_u32 s53, 9
    s_cbranch_scc1 L_hn_82
    s_cmp_lg_u32 s48, 0
    s_cbranch_scc1 L_w0_83
    v_cmp_ne_u32 vcc, 1, v201
    s_nop 3
    s_cbranch_vccz L_pd_85
    s_mov_b32 s60, 0x200000
L_p_84:
    v_and_b32 v200, 7, v0
    buffer_load_ubyte v201, v200, s[96:99], 0 offen offset:144 sc1
    s_waitcnt vmcnt(0)
    v_cmp_ne_u32 vcc, 1, v201
    s_nop 3
    s_cbranch_vccz L_done_86
    s_sub_u32 s60, s60, 1
    s_cbranch_scc0 L_p_84
L_done_86:
L_pd_85:
L_w0_83:
    s_branch L_fb_16
L_hn_82:
    s_cmp_lg_u32 s53, 5
    s_cbranch_scc1 L_hn_87
    s_cmp_lg_u32 s48, 0
    s_cbranch_scc1 L_w0_88
    v_cmp_ne_u32 vcc, 1, v201
    s_nop 3
    s_cbranch_vccz L_w0_88
    s_waitcnt vmcnt(0)
L_w0_88:
    s_branch L_fb_16
L_hn_87:
    s_cmp_lg_u32 s53, 4
    s_cbranch_scc1 L_hn_89
    s_cmp_lg_u32 s48, 0
    s_cbranch_scc1 L_w0_90
    v_cmp_ne_u32 vcc, 1, v201
    s_nop 3
    s_cbranch_vccz L_w0_90
    s_waitcnt vmcnt(0)
L_w0_90:
    s_branch L_fb_16
L_hn_89:
    s_cmp_lg_u32 s53, 3
    s_cbranch_scc1 L_hn_91
    s_cmp_lg_u32 s48, 0
    s_cbranch_scc1 L_w0_92
    v_cmp_ne_u32 vcc, 1, v201
    s_nop 3
    s_cbranch_vccz L_pd_94
    s_mov_b32 s60, 0x200000
L_p_93:
    v_and_b32 v200, 7, v0
    buffer_load_ubyte v201, v200, s[96:99], 0 offen offset:152 sc1
    s_waitcnt vmcnt(0)
    v_cmp_ne_u32 vcc, 1, v201
    s_nop 3
    s_cbranch_vccz L_done_95
    s_sub_u32 s60, s60, 1
    s_cbranch_scc0 L_p_93
L_done_95:
L_pd_94:
L_w0_92:
    s_branch L_fb_16
L_hn_91:
    s_branch L_fb_16
L_fd_17:
    s_cmp_lg_u32 s53, 13
    s_cbranch_scc1 L_hn_96
    s_cmp_eq_u32 s94, 0
    s_cbranch_scc1 L_fp_97
    v_mov_b32 v204, 1
    v_mov_b32 v205, 0
    s_mov_b64 exec, 1
    buffer_store_byte v204, v205, s[96:99], s2 offen offset:144 sc1
    s_mov_b64 exec, -1
L_fp_97:
    s_branch L_fb_18
L_hn_96:
    s_cmp_lg_u32 s53, 12
    s_cbranch_scc1 L_hn_98
    s_cmp_lg_u32 s48, 0
    s_cbranch_scc1 L_w0_99
    v_and_b32 v200, 7, v0
    buffer_load_ubyte v201, v200, s[96:99], 0 offen offset:144 sc1
L_w0_99:
    s_branch L_fb_18
L_hn_98:
    s_cmp_lg_u32 s53, 11
    s_cbranch_scc1 L_hn_100
    s_cmp_lg_u32 s48, 0
    s_cbranch_scc1 L_w0_101
    v_and_b32 v200, 7, v0
    buffer_load_ubyte v201, v200, s[96:99], 0 offen offset:144 sc1
L_w0_101:
    s_branch L_fb_18
L_hn_100:
    s_cmp_lg_u32 s53, 10
    s_cbranch_scc1 L_hn_102
    s_cmp_lg_u32 s48, 0
    s_cbranch_scc1 L_w0_103
    v_and_b32 v200, 7, v0
    buffer_load_ubyte v201, v200, s[96:99], 0 offen offset:144 sc1
L_w0_103:
    s_branch L_fb_18
L_hn_102:
    s_cmp_lg_u32 s53, 7
    s_cbranch_scc1 L_hn_104
    s_cmp_eq_u32 s94, 0
    s_cbranch_scc1 L_fp_105
    v_mov_b32 v204, 1
    v_mov_b32 v205, 0
    s_mov_b64 exec, 1
    buffer_store_byte v204, v205, s[96:99], s2 offen offset:152 sc1
    s_mov_b64 exec, -1
L_fp_105:
    s_branch L_fb_18
L_hn_104:
    s_cmp_lg_u32 s53, 6
    s_cbranch_scc1 L_hn_106
    s_cmp_lg_u32 s48, 0
    s_cbranch_scc1 L_w0_107
    v_and_b32 v200, 7, v0
    buffer_load_ubyte v201, v200, s[96:99], 0 offen offset:152 sc1
L_w0_107:
    s_branch L_fb_18
L_hn_106:
    s_cmp_lg_u32 s53, 5
    s_cbranch_scc1 L_hn_108
    s_cmp_lg_u32 s48, 0
    s_cbranch_scc1 L_w0_109
    v_and_b32 v200, 7, v0
    buffer_load_ubyte v201, v200, s[96:99], 0 offen offset:152 sc1
L_w0_109:
    s_branch L_fb_18
L_hn_108:
    s_cmp_lg_u32 s53, 4
    s_cbranch_scc1 L_hn_110
    s_cmp_lg_u32 s48, 0
    s_cbranch_scc1 L_w0_111
    v_and_b32 v200, 7, v0
    buffer_load_ubyte v201, v200, s[96:99], 0 offen offset:152 sc1
L_w0_111:
    s_branch L_fb_18
L_hn_110:
    s_branch L_fb_18
L_hd_26:
    s_cmp_lg_u32 s53, 15
    s_cbranch_scc1 L_hn_112
    s_cmp_lg_u32 s48, 0
    s_cbranch_scc1 L_w0_113
    v_mov_b32 v204, 1
    v_mov_b32 v205, 0
    s_mov_b64 exec, 1
    s_lshl_b32 s59, s85, 2
    s_add_u32 s59, s59, s62
    buffer_store_dword v204, v205, s[40:43], s59 offen sc1
    s_mov_b64 exec, -1
L_w0_113:
    s_branch L_hb_25
L_hn_112:
    s_cmp_lg_u32 s53, 10
    s_cbranch_scc1 L_hn_114
    s_cmp_lg_u32 s48, 0
    s_cbranch_scc1 L_w0_115
    v_mov_b32 v205, 0
    buffer_load_dword v206, v205, s[96:99], 0 offen sc1
L_w0_115:
    s_branch L_hb_25
L_hn_114:
    s_cmp_lg_u32 s53, 8
    s_cbranch_scc1 L_hn_116
    s_cmp_lg_u32 s48, 0
    s_cbranch_scc1 L_w0_117
    v_cmp_ne_u32 vcc, 0x100, v206
    s_nop 3
    s_cbranch_vccz L_pd_119
    s_mov_b32 s60, 0x200000
    v_mov_b32 v205, 0
L_p_118:
    buffer_load_dword v204, v205, s[96:99], 0 offen sc1
    s_waitcnt vmcnt(0)
    v_cmp_ne_u32 vcc, 0x100, v204
    s_nop 3
    s_cbranch_vccz L_done_120
    s_sub_u32 s60, s60, 1
    s_cbranch_scc0 L_p_118
L_done_120:
L_pd_119:
L_w0_117:
    s_branch L_hb_25
L_hn_116:
    s_cmp_lg_u32 s53, 6
    s_cbranch_scc1 L_hn_121
    s_cmp_lg_u32 s48, 0
    s_cbranch_scc1 L_w0_122
    v_and_b32 v205, 3, v0
    v_lshlrev_b32 v205, 2, v205
    s_mov_b32 s59, s62
    buffer_load_dword v207, v205, s[40:43], s59 offen sc1
L_w0_122:
    s_branch L_hb_25
L_hn_121:
    s_cmp_lg_u32 s53, 4
    s_cbranch_scc1 L_hn_123
    s_cmp_lg_u32 s48, 0
    s_cbranch_scc1 L_w0_124
    v_cmp_ne_u32 vcc, 1, v207
    s_nop 3
    s_cbranch_vccz L_pd_126
    s_mov_b32 s60, 0x200000
L_p_125:
    v_and_b32 v205, 3, v0
    v_lshlrev_b32 v205, 2, v205
    s_mov_b32 s59, s62
    buffer_load_dword v204, v205, s[40:43], s59 offen sc1
    s_waitcnt vmcnt(0)
    v_cmp_ne_u32 vcc, 1, v204
    s_nop 3
    s_cbranch_vccz L_done_127
    s_sub_u32 s60, s60, 1
    s_cbranch_scc0 L_p_125
L_done_127:
L_pd_126:
L_w0_124:
    s_branch L_hb_25
L_hn_123:
    s_cmp_lg_u32 s53, 2
    s_cbranch_scc1 L_hn_128
    v_add_u32 v198, 98304, v24
    v_add_u32 v199, 98304, v25
    ds_read_b64_tr_b16 a[112:113], v198 offset:0
    ds_read_b64_tr_b16 a[114:115], v198 offset:4096
    ds_read_b64_tr_b16 a[116:117], v199 offset:0
    ds_read_b64_tr_b16 a[118:119], v199 offset:4096
    ds_read_b64_tr_b16 a[120:121], v198 offset:8192
    ds_read_b64_tr_b16 a[122:123], v198 offset:12288
    ds_read_b64_tr_b16 a[124:125], v199 offset:8192
    ds_read_b64_tr_b16 a[126:127], v199 offset:12288
    ds_read_b64_tr_b16 a[128:129], v198 offset:16384
    ds_read_b64_tr_b16 a[130:131], v198 offset:20480
    ds_read_b64_tr_b16 a[132:133], v199 offset:16384
    ds_read_b64_tr_b16 a[134:135], v199 offset:20480
    ds_read_b64_tr_b16 a[136:137], v198 offset:24576
    ds_read_b64_tr_b16 a[138:139], v198 offset:28672
    ds_read_b64_tr_b16 a[140:141], v199 offset:24576
    ds_read_b64_tr_b16 a[142:143], v199 offset:28672
    ds_read_b64_tr_b16 a[144:145], v198 offset:32768
    ds_read_b64_tr_b16 a[146:147], v198 offset:36864
    ds_read_b64_tr_b16 a[148:149], v199 offset:32768
    ds_read_b64_tr_b16 a[150:151], v199 offset:36864
    ds_read_b64_tr_b16 a[152:153], v198 offset:40960
    ds_read_b64_tr_b16 a[154:155], v198 offset:45056
    ds_read_b64_tr_b16 a[156:157], v199 offset:40960
    ds_read_b64_tr_b16 a[158:159], v199 offset:45056
    ds_read_b64_tr_b16 a[160:161], v198 offset:49152
    ds_read_b64_tr_b16 a[162:163], v198 offset:53248
    ds_read_b64_tr_b16 a[164:165], v199 offset:49152
    ds_read_b64_tr_b16 a[166:167], v199 offset:53248
    ds_read_b64_tr_b16 a[168:169], v198 offset:57344
    ds_read_b64_tr_b16 a[170:171], v198 offset:61440
    ds_read_b64_tr_b16 a[172:173], v199 offset:57344
    ds_read_b64_tr_b16 a[174:175], v199 offset:61440
    s_waitcnt lgkmcnt(0)
    s_branch L_hb_25
L_hn_128:
    s_branch L_hb_25
L_codeend:
    s_endpgm
.section .rodata,"a"
.p2align 6
.amdhsa_kernel standalone__mha_block_cached__near_ridge_kernel
  .amdhsa_next_free_vgpr 512
  .amdhsa_next_free_sgpr 100
  .amdhsa_accum_offset 256
  .amdhsa_group_segment_fixed_size 0
  .amdhsa_kernarg_size 64
  .amdhsa_user_sgpr_count 2
  .amdhsa_user_sgpr_kernarg_segment_ptr 1
  .amdhsa_system_sgpr_workgroup_id_x 1
  .amdhsa_float_denorm_mode_32 3
.end_amdhsa_kernel
```
